```python
import torch

def _softmax(x, axis=-1):
    return torch.softmax(x, dim=axis)
def _gelu(x):
    return torch.nn.functional.gelu(x, approximate="tanh")
def _silu(x):
    return torch.nn.functional.silu(x)
def _sigmoid(x):
    return torch.sigmoid(x)
def _layernorm(x, axis=-1, eps=1e-5):
    m = x.mean(dim=axis, keepdim=True)
    v = x.var(dim=axis, keepdim=True, unbiased=False)
    return (x - m) / torch.sqrt(v + eps)
def _scatter_add(tgt, idx, src, axis=0):
    return tgt.clone().index_add_(axis, idx, src)
def _segment_sum(src, seg, n):
    out = torch.zeros((n,) + src.shape[1:], dtype=src.dtype)
    return out.index_add_(0, seg, src)
def _pad(x, pw):
    flat = tuple(v for pair in reversed(pw) for v in pair)
    return torch.nn.functional.pad(x, flat)

kernel_name = 'interleave_layers__sliding_block__mixer_channel_mlp__prompt'

def setup_inputs():

    _w = (lambda a: (lambda t: t.to(torch.bfloat16) if t.is_floating_point() else t)(torch.as_tensor(a)))
    def _A_setup():
        B, S, D = 1, 2048, 448
        return {
            "x": _w((lambda *s: torch.randn(*s, dtype=torch.bfloat16) * 0.05)(B, S, D)),
            "wqkv": _w((lambda *s: torch.randn(*s, dtype=torch.bfloat16) * 0.05)(D, 3 * D)),
            "wo": _w((lambda *s: torch.randn(*s, dtype=torch.bfloat16) * 0.05)(D, D)),
        }
    _A_in = _A_setup()

    def _B_setup():
        B, S, D, F = 1, 2048, 448, 1792
        return {
            "x": _w((lambda *s: torch.randn(*s, dtype=torch.bfloat16) * 0.05)(B, S, D)),
            "w1": _w((lambda *s: torch.randn(*s, dtype=torch.bfloat16) * 0.8)(D, F) * (D ** -0.5)),
            "b1": _w((lambda *s: torch.randn(*s, dtype=torch.bfloat16) * 0.8)(F)),
            "w2": _w((lambda *s: torch.randn(*s, dtype=torch.bfloat16) * 0.8)(F, D) * (F ** -0.5)),
            "b2": _w((lambda *s: torch.randn(*s, dtype=torch.bfloat16) * 0.4)(D)),
        }
    _B_in = _B_setup()

    return {
        "A_x": _A_in["x"],
        "A_wqkv": _A_in["wqkv"],
        "A_wo": _A_in["wo"],
        "B_x": _B_in["x"],
        "B_w1": _B_in["w1"],
        "B_b1": _B_in["b1"],
        "B_w2": _B_in["w2"],
        "B_b2": _B_in["b2"],
    }

def reference(A_x, A_wqkv, A_wo, B_x, B_w1, B_b1, B_w2, B_b2):
    def _A_ref(x, wqkv, wo):
        B, S, D = x.shape
        H = 16; Dh = D // H; W = 256
        qkv = (lambda x, *d: x.permute(*d))((x @ wqkv).reshape(B, S, 3, H, Dh), 2, 0, 3, 1, 4)
        q, k, v = qkv[0], qkv[1], qkv[2]
        scores = torch.einsum("bhqd,bhkd->bhqk", q, k) * (Dh ** -0.5)
        idx = torch.arange(S)
        mask = (idx[:, None] - idx[None, :] >= 0) & (idx[:, None] - idx[None, :] < W)
        scores = torch.where(mask[None, None], scores, -1e9)
        p = _softmax(scores, axis=-1)
        o = torch.einsum("bhqk,bhkd->bhqd", p, v)
        return (lambda x, *d: x.permute(*d))(o, 0, 2, 1, 3).reshape(B, S, D) @ wo

    def _B_ref(x, w1, b1, w2, b2):
        y = _layernorm(x, axis=-1)
        h = _gelu(torch.einsum("bsd,df->bsf", y, w1) + b1)
        return torch.einsum("bsf,fd->bsd", h, w2) + b2

    x = A_x
    x = x + _A_ref(_layernorm(x, axis=-1), A_wqkv, A_wo)
    x = x + _B_ref(_layernorm(x, axis=-1), B_w1, B_b1, B_w2, B_b2)
    x = x + _A_ref(_layernorm(x, axis=-1), A_wqkv, A_wo)
    x = x + _B_ref(_layernorm(x, axis=-1), B_w1, B_b1, B_w2, B_b2)
    return x
```

```asm
; @launch grid=(256,1,1) block=(512,1,1) lds=163840
.amdgcn_target "amdgcn-amd-amdhsa--gfx950"
.text
.globl interleave_layers__sliding_block__mixer_channel_mlp__prompt_kernel
.p2align 8
.type interleave_layers__sliding_block__mixer_channel_mlp__prompt_kernel,@function
interleave_layers__sliding_block__mixer_channel_mlp__prompt_kernel:
    s_cmp_ge_u32 s2, 256
    s_cbranch_scc1 L_end
    s_load_dwordx2 s[4:5], s[0:1], 8
    s_load_dwordx2 s[32:33], s[0:1], 0
    s_load_dwordx2 s[8:9], s[0:1], 80
    s_load_dwordx2 s[12:13], s[0:1], 16
    s_load_dwordx2 s[16:17], s[0:1], 32
    s_load_dwordx2 s[20:21], s[0:1], 48
    s_load_dwordx2 s[24:25], s[0:1], 64
    s_load_dwordx2 s[28:29], s[0:1], 56
    s_load_dwordx2 s[36:37], s[0:1], 40
    s_load_dwordx2 s[40:41], s[0:1], 72
    s_getpc_b64 s[58:59]
L_pc:
    s_sub_u32 s58, s58, L_pc-interleave_layers__sliding_block__mixer_channel_mlp__prompt_kernel
    s_subb_u32 s59, s59, 0
    s_lshr_b32 s52, s2, 3
    s_lshl_b32 s52, s52, 11
    v_lshl_add_u32 v23, v0, 7, s52
    v_min_u32 v23, L_end-interleave_layers__sliding_block__mixer_channel_mlp__prompt_kernel, v23
    v_cmp_gt_u32 vcc, 16, v0
    s_nop 1
    s_and_saveexec_b64 s[56:57], vcc
    s_cbranch_execz L_nopf
    global_load_dword v28, v23, s[58:59]
L_nopf:
    s_mov_b64 exec, -1
    s_mov_b32 s6, 0x126000
    s_mov_b32 s7, 0x00020000
    s_mov_b32 s34, 0x1c0000
    s_mov_b32 s35, 0x00020000
    s_mov_b32 s10, 0x10000000
    s_mov_b32 s11, 0x00020000
    s_mov_b32 s14, 0x62000
    s_mov_b32 s15, 0x00020000
    s_mov_b32 s18, 0x188000
    s_mov_b32 s19, 0x00020000
    s_mov_b32 s22, 0x188000
    s_mov_b32 s23, 0x00020000
    s_mov_b32 s26, 0x1c0000
    s_mov_b32 s27, 0x00020000
    s_mov_b32 s30, 0x380
    s_mov_b32 s31, 0x00020000
    s_mov_b32 s38, 0xe00
    s_mov_b32 s39, 0x00020000
    s_mov_b32 s42, 0x100
    s_mov_b32 s43, 0x00020000
    s_and_b32 s44, s2, 7
    s_lshl_b32 s44, s44, 1
    s_lshr_b32 s52, s2, 3
    s_and_b32 s52, s52, 1
    s_or_b32 s44, s44, s52
    s_lshr_b32 s45, s2, 4
    v_lshrrev_b32 v1, 6, v0
    s_nop 0
    v_readfirstlane_b32 s55, v1
    v_and_b32 v1, 63, v0
    s_nop 0
    s_and_b32 s46, s55, 3
    s_lshl_b32 s47, s44, 2
    s_add_u32 s47, s47, s46
    s_lshl_b32 s60, s46, 10
    s_mul_i32 s48, s47, 208896
    s_lshl_b32 s49, s47, 9
    s_add_u32 s49, s49, 21757952
    s_lshl_b32 s65, s45, 6
    s_add_u32 s65, s65, s47
    s_lshl_b32 s65, s65, 12
    s_add_u32 s65, s65, 13369344
    s_lshl_b32 s62, s45, 1
    s_sub_u32 s52, s62, 13
    s_cmp_ge_u32 s45, 7
    s_cselect_b32 s62, s52, s62
    s_mov_b32 s63, 0
    s_mov_b32 s64, 57344
    v_lshlrev_b32 v2, 4, v1
    v_and_b32 v20, 31, v1
    v_lshrrev_b32 v21, 5, v1
    v_lshlrev_b32 v6, 3, v20
    s_mov_b32 s52, 1792
    v_mul_lo_u32 v22, v21, s52
    v_add_u32 v6, v6, v22
    v_lshlrev_b32 v7, 2, v20
    v_mov_b32 v9, 1
    v_mov_b32 v10, 0
    v_lshlrev_b32 v22, 2, v21
    v_sub_u32 v11, v20, v22
    v_mov_b32 v12, 0xff800000
    s_mov_b32 s50, 0
    s_mov_b32 s61, 0
    s_mov_b32 s94, 0
    v_mov_b32 v24, 0
    v_mov_b32 v25, 0
    v_mov_b32 v26, 0
    v_mov_b32 v27, 0
    v_add_u32 v22, s60, v2
    v_add_u32 v22, 131072, v22
    ds_write_b128 v22, v[24:27]
    s_waitcnt lgkmcnt(0)
    s_lshr_b32 s52, s2, 3
    s_lshl_b32 s52, s52, 3
    s_add_u32 s52, s52, s55
    s_mul_i32 s53, s52, 4736
    s_mul_i32 s54, s52, 896
    s_and_b32 s56, s2, 7
    s_mul_i32 s56, s56, 229376
    s_add_u32 s54, s54, s56
    v_lshlrev_b32 v23, 7, v1
    s_mov_b64 exec, 0x7f
    buffer_load_dword v0, v23, s[32:35], s54 offen sc1
    s_mov_b32 s58, -1
    s_mov_b32 s59, 31
    s_mov_b64 exec, s[58:59]
    buffer_load_dword v17, v23, s[4:7], s53 offen sc1
    s_lshl_b32 s52, s2, 3
    s_add_u32 s52, s52, s55
    s_mul_i32 s53, s52, 896
    s_lshl_b32 s54, s52, 8
    s_mov_b64 exec, 0x7f
    buffer_load_dword v13, v23, s[16:19], s53 offen sc1
    buffer_load_dword v14, v23, s[20:23], s53 offen sc1
    s_mov_b64 exec, 3
    buffer_load_dword v15, v23, s[12:15], s54 offen sc1
    s_mov_b64 exec, -1
    s_waitcnt vmcnt(0)
    s_barrier
    s_cmp_ge_u32 s55, 4
    s_cbranch_scc1 L_helper
    s_lshl_b32 s54, s45, 2
    s_add_u32 s54, s54, s46
    s_lshr_b32 s55, s54, 5
    s_mul_i32 s55, s55, 180224
    s_and_b32 s54, s54, 31
    s_lshl_b32 s54, s54, 6
    s_add_u32 s54, s54, s55
    s_lshl_b32 s55, s44, 11
    s_add_u32 s54, s54, s55
    s_add_u32 s54, s54, 21757952
    v_add_u32 v180, s54, v7
    s_mul_i32 s55, s45, 72
    s_add_u32 s55, s55, s47
    s_lshl_b32 s55, s55, 7
    s_lshl_b32 s54, s47, 9
    s_sub_u32 s54, s49, s54
    s_add_u32 s54, s54, s55
    s_add_u32 s54, s54, 33792
    v_writelane_b32 v180, s54, 16
    s_add_u32 s55, s54, 180224
    v_writelane_b32 v180, s55, 17
    s_sub_u32 s54, s54, 508
    v_writelane_b32 v180, s54, 18
    s_add_u32 s55, s54, 180224
    v_writelane_b32 v180, s55, 19
    s_lshl_b32 s54, s44, 4
    s_add_u32 s54, s54, s45
    s_lshl_b32 s54, s54, 7
    s_add_u32 s54, s54, 22118400
    v_writelane_b32 v180, s54, 20
    s_cmp_eq_u32 s46, 0
    s_mov_b32 s86, 0xfffff
    s_cselect_b32 s86, 0x1fffff, s86
    s_mov_b32 s87, 0
    s_lshl_b32 s72, s46, 14
    s_add_u32 s72, s72, 86016
    s_cmp_eq_u32 s46, 2
    s_cselect_b32 s72, 135168, s72
    v_lshrrev_b32 v170, 3, v1
    v_and_b32 v171, 7, v1
    v_xor_b32 v171, v171, v170
    s_mov_b32 s52, 896
    v_mul_lo_u32 v170, v170, s52
    v_lshl_add_u32 v170, v171, 4, v170
    s_mul_i32 s53, s47, 28672
    s_mov_b32 s85, s53
    s_cmp_eq_u32 s46, 3
    s_cselect_b32 s72, 118784, s72
    s_add_u32 s84, s72, 12288
    s_cmp_eq_u32 s46, 3
    s_cselect_b32 s84, 151552, s84
    s_add_u32 m0, s72, 0
    s_add_u32 s52, s85, 0
    buffer_load_dwordx4 v170, s[32:35], s52 offen lds
    s_add_u32 m0, s72, 1024
    s_add_u32 s52, s85, 7168
    buffer_load_dwordx4 v170, s[32:35], s52 offen lds
    s_add_u32 m0, s72, 2048
    s_add_u32 s52, s85, 14336
    buffer_load_dwordx4 v170, s[32:35], s52 offen lds
    s_add_u32 m0, s72, 3072
    s_add_u32 s52, s85, 21504
    buffer_load_dwordx4 v170, s[32:35], s52 offen lds
    s_add_u32 m0, s72, 4096
    s_add_u32 s52, s85, 128
    buffer_load_dwordx4 v170, s[32:35], s52 offen lds
    s_add_u32 m0, s72, 5120
    s_add_u32 s52, s85, 7296
    buffer_load_dwordx4 v170, s[32:35], s52 offen lds
    s_add_u32 m0, s72, 6144
    s_add_u32 s52, s85, 14464
    buffer_load_dwordx4 v170, s[32:35], s52 offen lds
    s_add_u32 m0, s72, 7168
    s_add_u32 s52, s85, 21632
    buffer_load_dwordx4 v170, s[32:35], s52 offen lds
    s_add_u32 m0, s72, 8192
    s_add_u32 s52, s85, 256
    buffer_load_dwordx4 v170, s[32:35], s52 offen lds
    s_add_u32 m0, s72, 9216
    s_add_u32 s52, s85, 7424
    buffer_load_dwordx4 v170, s[32:35], s52 offen lds
    s_add_u32 m0, s72, 10240
    s_add_u32 s52, s85, 14592
    buffer_load_dwordx4 v170, s[32:35], s52 offen lds
    s_add_u32 m0, s72, 11264
    s_add_u32 s52, s85, 21760
    buffer_load_dwordx4 v170, s[32:35], s52 offen lds
    s_add_u32 m0, s84, 0
    s_add_u32 s52, s85, 384
    buffer_load_dwordx4 v170, s[32:35], s52 offen lds
    s_add_u32 m0, s84, 1024
    s_add_u32 s52, s85, 7552
    buffer_load_dwordx4 v170, s[32:35], s52 offen lds
    s_add_u32 m0, s84, 2048
    s_add_u32 s52, s85, 14720
    buffer_load_dwordx4 v170, s[32:35], s52 offen lds
    s_add_u32 m0, s84, 3072
    s_add_u32 s52, s85, 21888
    buffer_load_dwordx4 v170, s[32:35], s52 offen lds
    s_mov_b64 exec, s[86:87]
    buffer_store_dword v10, v180, s[8:11], 0 offen sc1
    s_mov_b64 exec, -1
    v_and_b32 v160, 31, v1
    v_lshrrev_b32 v161, 5, v1
    s_mov_b32 s52, 896
    v_mul_lo_u32 v168, v160, s52
    v_lshl_add_u32 v168, v161, 3, v168
    s_min_u32 s55, s62, 13
    s_lshl_b32 s54, s55, 6
    s_add_u32 s53, s53, s54
    v_lshlrev_b32 v169, 3, v161
    buffer_load_dwordx2 v[24:25], v168, s[32:35], s53 offen offset:0
    buffer_load_dwordx2 v[26:27], v168, s[32:35], s53 offen offset:16
    buffer_load_dwordx2 v[28:29], v168, s[32:35], s53 offen offset:32
    buffer_load_dwordx2 v[30:31], v168, s[32:35], s53 offen offset:48
    buffer_load_dwordx2 v[32:33], v169, s[28:31], s54 offen offset:0
    buffer_load_dwordx2 v[34:35], v169, s[28:31], s54 offen offset:16
    buffer_load_dwordx2 v[36:37], v169, s[28:31], s54 offen offset:32
    buffer_load_dwordx2 v[38:39], v169, s[28:31], s54 offen offset:48
    v_lshrrev_b32 v160, 5, v1
    v_lshlrev_b32 v160, 8, v160
    v_bfe_u32 v161, v1, 2, 2
    v_lshl_add_u32 v160, v161, 6, v160
    v_bfe_u32 v161, v1, 4, 1
    v_lshl_add_u32 v160, v161, 5, v160
    v_and_b32 v161, 3, v1
    v_lshl_add_u32 v18, v161, 3, v160
    v_add_u32 v5, 114688, v18
    v_add_u32 v13, 4096, v2
    v_and_b32 v160, 31, v1
    v_lshrrev_b32 v161, 5, v1
    s_mul_i32 s54, s45, 7
    v_add_u32 v162, s54, v161
    v_lshrrev_b32 v163, 2, v162
    v_lshlrev_b32 v163, 10, v163
    v_and_b32 v164, 1, v162
    v_lshl_add_u32 v163, v164, 9, v163
    v_bfe_u32 v164, v162, 1, 1
    v_lshl_add_u32 v163, v164, 3, v163
    v_lshl_add_u32 v14, v160, 4, v163
    v_add_u32 v162, s54, v161
    v_add_u32 v162, 2, v162
    v_lshrrev_b32 v163, 2, v162
    v_lshlrev_b32 v163, 10, v163
    v_and_b32 v164, 1, v162
    v_lshl_add_u32 v163, v164, 9, v163
    v_bfe_u32 v164, v162, 1, 1
    v_lshl_add_u32 v163, v164, 3, v163
    v_lshl_add_u32 v15, v160, 4, v163
    v_add_u32 v162, s54, v161
    v_add_u32 v162, 4, v162
    v_lshrrev_b32 v163, 2, v162
    v_lshlrev_b32 v163, 10, v163
    v_and_b32 v164, 1, v162
    v_lshl_add_u32 v163, v164, 9, v163
    v_bfe_u32 v164, v162, 1, 1
    v_lshl_add_u32 v163, v164, 3, v163
    v_lshl_add_u32 v16, v160, 4, v163
    v_add_u32 v162, s54, v161
    v_add_u32 v162, 6, v162
    v_lshrrev_b32 v163, 2, v162
    v_lshlrev_b32 v163, 10, v163
    v_and_b32 v164, 1, v162
    v_lshl_add_u32 v163, v164, 9, v163
    v_bfe_u32 v164, v162, 1, 1
    v_lshl_add_u32 v163, v164, 3, v163
    v_lshl_add_u32 v17, v160, 4, v163
    v_subrev_u32 v162, 0, v11
    v_cmp_eq_u32 vcc, 0, v162
    v_mov_b32 v163, 0x3f80
    s_nop 0
    v_cndmask_b32 v40, 0, v163, vcc
    v_cmp_eq_u32 vcc, 1, v162
    v_mov_b32 v163, 0x3f800000
    s_nop 0
    v_cndmask_b32 v40, v40, v163, vcc
    v_subrev_u32 v162, 2, v11
    v_cmp_eq_u32 vcc, 0, v162
    v_mov_b32 v163, 0x3f80
    s_nop 0
    v_cndmask_b32 v41, 0, v163, vcc
    v_cmp_eq_u32 vcc, 1, v162
    v_mov_b32 v163, 0x3f800000
    s_nop 0
    v_cndmask_b32 v41, v41, v163, vcc
    v_subrev_u32 v162, 8, v11
    v_cmp_eq_u32 vcc, 0, v162
    v_mov_b32 v163, 0x3f80
    s_nop 0
    v_cndmask_b32 v42, 0, v163, vcc
    v_cmp_eq_u32 vcc, 1, v162
    v_mov_b32 v163, 0x3f800000
    s_nop 0
    v_cndmask_b32 v42, v42, v163, vcc
    v_subrev_u32 v162, 10, v11
    v_cmp_eq_u32 vcc, 0, v162
    v_mov_b32 v163, 0x3f80
    s_nop 0
    v_cndmask_b32 v43, 0, v163, vcc
    v_cmp_eq_u32 vcc, 1, v162
    v_mov_b32 v163, 0x3f800000
    s_nop 0
    v_cndmask_b32 v43, v43, v163, vcc
    v_subrev_u32 v162, 16, v11
    v_cmp_eq_u32 vcc, 0, v162
    v_mov_b32 v163, 0x3f80
    s_nop 0
    v_cndmask_b32 v44, 0, v163, vcc
    v_cmp_eq_u32 vcc, 1, v162
    v_mov_b32 v163, 0x3f800000
    s_nop 0
    v_cndmask_b32 v44, v44, v163, vcc
    v_subrev_u32 v162, 18, v11
    v_cmp_eq_u32 vcc, 0, v162
    v_mov_b32 v163, 0x3f80
    s_nop 0
    v_cndmask_b32 v45, 0, v163, vcc
    v_cmp_eq_u32 vcc, 1, v162
    v_mov_b32 v163, 0x3f800000
    s_nop 0
    v_cndmask_b32 v45, v45, v163, vcc
    v_subrev_u32 v162, 24, v11
    v_cmp_eq_u32 vcc, 0, v162
    v_mov_b32 v163, 0x3f80
    s_nop 0
    v_cndmask_b32 v46, 0, v163, vcc
    v_cmp_eq_u32 vcc, 1, v162
    v_mov_b32 v163, 0x3f800000
    s_nop 0
    v_cndmask_b32 v46, v46, v163, vcc
    v_subrev_u32 v162, 26, v11
    v_cmp_eq_u32 vcc, 0, v162
    v_mov_b32 v163, 0x3f80
    s_nop 0
    v_cndmask_b32 v47, 0, v163, vcc
    v_cmp_eq_u32 vcc, 1, v162
    v_mov_b32 v163, 0x3f800000
    s_nop 0
    v_cndmask_b32 v47, v47, v163, vcc
    s_lshl_b32 s73, s62, 11
    s_add_u32 s73, s73, s48
    s_lshr_b32 s56, s62, 1
    s_sub_u32 s53, s45, s56
    s_lshl_b32 s74, 0x7f, s53
    s_lshl_b32 s54, 1, s45
    s_andn2_b32 s74, s74, s54
    s_add_u32 s54, s56, 1
    s_sub_u32 s55, s54, 7
    s_cmp_ge_u32 s54, 7
    s_cselect_b32 s54, s55, s54
    s_add_u32 s54, s54, s53
    s_lshl_b32 s54, s54, 13
    s_add_u32 s54, s54, s48
    s_add_u32 s66, s54, 94208
    s_add_u32 s54, s56, 2
    s_sub_u32 s55, s54, 7
    s_cmp_ge_u32 s54, 7
    s_cselect_b32 s54, s55, s54
    s_add_u32 s54, s54, s53
    s_lshl_b32 s54, s54, 13
    s_add_u32 s54, s54, s48
    s_add_u32 s67, s54, 94208
    s_add_u32 s54, s56, 3
    s_sub_u32 s55, s54, 7
    s_cmp_ge_u32 s54, 7
    s_cselect_b32 s54, s55, s54
    s_add_u32 s54, s54, s53
    s_lshl_b32 s54, s54, 13
    s_add_u32 s54, s54, s48
    s_add_u32 s68, s54, 94208
    s_add_u32 s54, s56, 4
    s_sub_u32 s55, s54, 7
    s_cmp_ge_u32 s54, 7
    s_cselect_b32 s54, s55, s54
    s_add_u32 s54, s54, s53
    s_lshl_b32 s54, s54, 13
    s_add_u32 s54, s54, s48
    s_add_u32 s69, s54, 94208
    s_add_u32 s54, s56, 5
    s_sub_u32 s55, s54, 7
    s_cmp_ge_u32 s54, 7
    s_cselect_b32 s54, s55, s54
    s_add_u32 s54, s54, s53
    s_lshl_b32 s54, s54, 13
    s_add_u32 s54, s54, s48
    s_add_u32 s70, s54, 94208
    s_add_u32 s54, s56, 6
    s_sub_u32 s55, s54, 7
    s_cmp_ge_u32 s54, 7
    s_cselect_b32 s54, s55, s54
    s_add_u32 s54, s54, s53
    s_lshl_b32 s54, s54, 13
    s_add_u32 s54, s54, s48
    s_add_u32 s71, s54, 94208
    v_mov_b32 v224, 0
    v_mov_b32 v225, 0
    v_mov_b32 v226, 0
    v_mov_b32 v227, 0
    v_mov_b32 v228, 0
    v_mov_b32 v229, 0
    v_mov_b32 v230, 0
    v_mov_b32 v231, 0
    v_mov_b32 v232, 0
    v_mov_b32 v233, 0
    v_mov_b32 v234, 0
    v_mov_b32 v235, 0
    v_mov_b32 v236, 0
    v_mov_b32 v237, 0
    v_mov_b32 v164, 0x3f803f80
    v_mov_b32 v166, 132548
    v_lshrrev_b32 v162, 3, v160
    v_lshlrev_b32 v162, 10, v162
    v_and_b32 v163, 7, v160
    v_lshl_add_u32 v162, v163, 7, v162
    v_add_u32 v165, 0, v161
    v_xor_b32 v165, v165, v163
    v_lshl_add_u32 v165, v165, 4, v162
    v_add_u32 v172, s72, v165
    v_add_u32 v176, s84, v165
    v_add_u32 v165, 2, v161
    v_xor_b32 v165, v165, v163
    v_lshl_add_u32 v165, v165, 4, v162
    v_add_u32 v173, s72, v165
    v_add_u32 v177, s84, v165
    v_add_u32 v165, 4, v161
    v_xor_b32 v165, v165, v163
    v_lshl_add_u32 v165, v165, 4, v162
    v_add_u32 v174, s72, v165
    v_add_u32 v178, s84, v165
    v_add_u32 v165, 6, v161
    v_xor_b32 v165, v165, v163
    v_lshl_add_u32 v165, v165, 4, v162
    v_add_u32 v175, s72, v165
    v_add_u32 v179, s84, v165
    s_waitcnt vmcnt(21)
    ds_read_b128 v[48:51], v172 offset:0
    ds_read_b128 v[52:55], v173 offset:0
    ds_read_b128 v[56:59], v174 offset:0
    ds_read_b128 v[60:63], v175 offset:0
    s_waitcnt lgkmcnt(0)
    s_add_u32 m0, s72, 0
    s_add_u32 s52, s85, 512
    buffer_load_dwordx4 v170, s[32:35], s52 offen lds
    s_add_u32 m0, s72, 1024
    s_add_u32 s52, s85, 7680
    buffer_load_dwordx4 v170, s[32:35], s52 offen lds
    s_add_u32 m0, s72, 2048
    s_add_u32 s52, s85, 14848
    buffer_load_dwordx4 v170, s[32:35], s52 offen lds
    s_add_u32 m0, s72, 3072
    s_add_u32 s52, s85, 22016
    buffer_load_dwordx4 v170, s[32:35], s52 offen lds
    v_dot2_f32_bf16 v224, v48, v164, v224
    v_dot2_f32_bf16 v225, v48, v48, v225
    v_dot2_f32_bf16 v226, v49, v164, v226
    v_dot2_f32_bf16 v227, v49, v49, v227
    v_dot2_f32_bf16 v224, v50, v164, v224
    v_dot2_f32_bf16 v225, v50, v50, v225
    v_dot2_f32_bf16 v226, v51, v164, v226
    v_dot2_f32_bf16 v227, v51, v51, v227
    v_permlane32_swap_b32 v48, v50
    v_permlane32_swap_b32 v49, v51
    v_dot2_f32_bf16 v224, v52, v164, v224
    v_dot2_f32_bf16 v225, v52, v52, v225
    v_dot2_f32_bf16 v226, v53, v164, v226
    v_dot2_f32_bf16 v227, v53, v53, v227
    v_dot2_f32_bf16 v224, v54, v164, v224
    v_dot2_f32_bf16 v225, v54, v54, v225
    v_dot2_f32_bf16 v226, v55, v164, v226
    v_dot2_f32_bf16 v227, v55, v55, v227
    v_permlane32_swap_b32 v52, v54
    v_permlane32_swap_b32 v53, v55
    v_dot2_f32_bf16 v224, v56, v164, v224
    v_dot2_f32_bf16 v225, v56, v56, v225
    v_dot2_f32_bf16 v226, v57, v164, v226
    v_dot2_f32_bf16 v227, v57, v57, v227
    v_dot2_f32_bf16 v224, v58, v164, v224
    v_dot2_f32_bf16 v225, v58, v58, v225
    v_dot2_f32_bf16 v226, v59, v164, v226
    v_dot2_f32_bf16 v227, v59, v59, v227
    v_permlane32_swap_b32 v56, v58
    v_permlane32_swap_b32 v57, v59
    v_dot2_f32_bf16 v224, v60, v164, v224
    v_dot2_f32_bf16 v225, v60, v60, v225
    v_dot2_f32_bf16 v226, v61, v164, v226
    v_dot2_f32_bf16 v227, v61, v61, v227
    v_dot2_f32_bf16 v224, v62, v164, v224
    v_dot2_f32_bf16 v225, v62, v62, v225
    v_dot2_f32_bf16 v226, v63, v164, v226
    v_dot2_f32_bf16 v227, v63, v63, v227
    v_permlane32_swap_b32 v60, v62
    v_permlane32_swap_b32 v61, v63
    s_waitcnt vmcnt(21)
    ds_read_b128 v[64:67], v172 offset:4096
    ds_read_b128 v[68:71], v173 offset:4096
    ds_read_b128 v[72:75], v174 offset:4096
    ds_read_b128 v[76:79], v175 offset:4096
    s_waitcnt lgkmcnt(0)
    s_add_u32 m0, s72, 4096
    s_add_u32 s52, s85, 640
    buffer_load_dwordx4 v170, s[32:35], s52 offen lds
    s_add_u32 m0, s72, 5120
    s_add_u32 s52, s85, 7808
    buffer_load_dwordx4 v170, s[32:35], s52 offen lds
    s_add_u32 m0, s72, 6144
    s_add_u32 s52, s85, 14976
    buffer_load_dwordx4 v170, s[32:35], s52 offen lds
    s_add_u32 m0, s72, 7168
    s_add_u32 s52, s85, 22144
    buffer_load_dwordx4 v170, s[32:35], s52 offen lds
    v_dot2_f32_bf16 v224, v64, v164, v224
    v_dot2_f32_bf16 v225, v64, v64, v225
    v_dot2_f32_bf16 v226, v65, v164, v226
    v_dot2_f32_bf16 v227, v65, v65, v227
    v_dot2_f32_bf16 v224, v66, v164, v224
    v_dot2_f32_bf16 v225, v66, v66, v225
    v_dot2_f32_bf16 v226, v67, v164, v226
    v_dot2_f32_bf16 v227, v67, v67, v227
    v_permlane32_swap_b32 v64, v66
    v_permlane32_swap_b32 v65, v67
    v_dot2_f32_bf16 v224, v68, v164, v224
    v_dot2_f32_bf16 v225, v68, v68, v225
    v_dot2_f32_bf16 v226, v69, v164, v226
    v_dot2_f32_bf16 v227, v69, v69, v227
    v_dot2_f32_bf16 v224, v70, v164, v224
    v_dot2_f32_bf16 v225, v70, v70, v225
    v_dot2_f32_bf16 v226, v71, v164, v226
    v_dot2_f32_bf16 v227, v71, v71, v227
    v_permlane32_swap_b32 v68, v70
    v_permlane32_swap_b32 v69, v71
    v_dot2_f32_bf16 v224, v72, v164, v224
    v_dot2_f32_bf16 v225, v72, v72, v225
    v_dot2_f32_bf16 v226, v73, v164, v226
    v_dot2_f32_bf16 v227, v73, v73, v227
    v_dot2_f32_bf16 v224, v74, v164, v224
    v_dot2_f32_bf16 v225, v74, v74, v225
    v_dot2_f32_bf16 v226, v75, v164, v226
    v_dot2_f32_bf16 v227, v75, v75, v227
    v_permlane32_swap_b32 v72, v74
    v_permlane32_swap_b32 v73, v75
    v_dot2_f32_bf16 v224, v76, v164, v224
    v_dot2_f32_bf16 v225, v76, v76, v225
    v_dot2_f32_bf16 v226, v77, v164, v226
    v_dot2_f32_bf16 v227, v77, v77, v227
    v_dot2_f32_bf16 v224, v78, v164, v224
    v_dot2_f32_bf16 v225, v78, v78, v225
    v_dot2_f32_bf16 v226, v79, v164, v226
    v_dot2_f32_bf16 v227, v79, v79, v227
    v_permlane32_swap_b32 v76, v78
    v_permlane32_swap_b32 v77, v79
    s_waitcnt vmcnt(21)
    ds_read_b128 v[80:83], v172 offset:8192
    ds_read_b128 v[84:87], v173 offset:8192
    ds_read_b128 v[88:91], v174 offset:8192
    ds_read_b128 v[92:95], v175 offset:8192
    s_waitcnt lgkmcnt(0)
    s_add_u32 m0, s72, 8192
    s_add_u32 s52, s85, 768
    buffer_load_dwordx4 v170, s[32:35], s52 offen lds
    s_add_u32 m0, s72, 9216
    s_add_u32 s52, s85, 7936
    buffer_load_dwordx4 v170, s[32:35], s52 offen lds
    s_add_u32 m0, s72, 10240
    s_add_u32 s52, s85, 15104
    buffer_load_dwordx4 v170, s[32:35], s52 offen lds
    s_add_u32 m0, s72, 11264
    s_add_u32 s52, s85, 22272
    buffer_load_dwordx4 v170, s[32:35], s52 offen lds
    v_dot2_f32_bf16 v224, v80, v164, v224
    v_dot2_f32_bf16 v225, v80, v80, v225
    v_dot2_f32_bf16 v226, v81, v164, v226
    v_dot2_f32_bf16 v227, v81, v81, v227
    v_dot2_f32_bf16 v224, v82, v164, v224
    v_dot2_f32_bf16 v225, v82, v82, v225
    v_dot2_f32_bf16 v226, v83, v164, v226
    v_dot2_f32_bf16 v227, v83, v83, v227
    v_permlane32_swap_b32 v80, v82
    v_permlane32_swap_b32 v81, v83
    v_dot2_f32_bf16 v224, v84, v164, v224
    v_dot2_f32_bf16 v225, v84, v84, v225
    v_dot2_f32_bf16 v226, v85, v164, v226
    v_dot2_f32_bf16 v227, v85, v85, v227
    v_dot2_f32_bf16 v224, v86, v164, v224
    v_dot2_f32_bf16 v225, v86, v86, v225
    v_dot2_f32_bf16 v226, v87, v164, v226
    v_dot2_f32_bf16 v227, v87, v87, v227
    v_permlane32_swap_b32 v84, v86
    v_permlane32_swap_b32 v85, v87
    v_dot2_f32_bf16 v224, v88, v164, v224
    v_dot2_f32_bf16 v225, v88, v88, v225
    v_dot2_f32_bf16 v226, v89, v164, v226
    v_dot2_f32_bf16 v227, v89, v89, v227
    v_dot2_f32_bf16 v224, v90, v164, v224
    v_dot2_f32_bf16 v225, v90, v90, v225
    v_dot2_f32_bf16 v226, v91, v164, v226
    v_dot2_f32_bf16 v227, v91, v91, v227
    v_permlane32_swap_b32 v88, v90
    v_permlane32_swap_b32 v89, v91
    v_dot2_f32_bf16 v224, v92, v164, v224
    v_dot2_f32_bf16 v225, v92, v92, v225
    v_dot2_f32_bf16 v226, v93, v164, v226
    v_dot2_f32_bf16 v227, v93, v93, v227
    v_dot2_f32_bf16 v224, v94, v164, v224
    v_dot2_f32_bf16 v225, v94, v94, v225
    v_dot2_f32_bf16 v226, v95, v164, v226
    v_dot2_f32_bf16 v227, v95, v95, v227
    v_permlane32_swap_b32 v92, v94
    v_permlane32_swap_b32 v93, v95
    s_waitcnt vmcnt(21)
    ds_read_b128 v[96:99], v176
    ds_read_b128 v[100:103], v177
    ds_read_b128 v[104:107], v178
    ds_read_b128 v[108:111], v179
    s_waitcnt lgkmcnt(3)
    v_dot2_f32_bf16 v224, v96, v164, v224
    v_dot2_f32_bf16 v225, v96, v96, v225
    v_dot2_f32_bf16 v226, v97, v164, v226
    v_dot2_f32_bf16 v227, v97, v97, v227
    v_dot2_f32_bf16 v224, v98, v164, v224
    v_dot2_f32_bf16 v225, v98, v98, v225
    v_dot2_f32_bf16 v226, v99, v164, v226
    v_dot2_f32_bf16 v227, v99, v99, v227
    v_permlane32_swap_b32 v96, v98
    v_permlane32_swap_b32 v97, v99
    s_waitcnt lgkmcnt(2)
    v_dot2_f32_bf16 v224, v100, v164, v224
    v_dot2_f32_bf16 v225, v100, v100, v225
    v_dot2_f32_bf16 v226, v101, v164, v226
    v_dot2_f32_bf16 v227, v101, v101, v227
    v_dot2_f32_bf16 v224, v102, v164, v224
    v_dot2_f32_bf16 v225, v102, v102, v225
    v_dot2_f32_bf16 v226, v103, v164, v226
    v_dot2_f32_bf16 v227, v103, v103, v227
    v_permlane32_swap_b32 v100, v102
    v_permlane32_swap_b32 v101, v103
    s_waitcnt lgkmcnt(1)
    v_dot2_f32_bf16 v224, v104, v164, v224
    v_dot2_f32_bf16 v225, v104, v104, v225
    v_dot2_f32_bf16 v226, v105, v164, v226
    v_dot2_f32_bf16 v227, v105, v105, v227
    v_dot2_f32_bf16 v224, v106, v164, v224
    v_dot2_f32_bf16 v225, v106, v106, v225
    v_dot2_f32_bf16 v226, v107, v164, v226
    v_dot2_f32_bf16 v227, v107, v107, v227
    v_permlane32_swap_b32 v104, v106
    v_permlane32_swap_b32 v105, v107
    s_waitcnt lgkmcnt(0)
    v_dot2_f32_bf16 v224, v108, v164, v224
    v_dot2_f32_bf16 v225, v108, v108, v225
    v_dot2_f32_bf16 v226, v109, v164, v226
    v_dot2_f32_bf16 v227, v109, v109, v227
    v_dot2_f32_bf16 v224, v110, v164, v224
    v_dot2_f32_bf16 v225, v110, v110, v225
    v_dot2_f32_bf16 v226, v111, v164, v226
    v_dot2_f32_bf16 v227, v111, v111, v227
    v_permlane32_swap_b32 v108, v110
    v_permlane32_swap_b32 v109, v111
    s_waitcnt vmcnt(8)
    ds_read_b128 v[112:115], v172 offset:0
    ds_read_b128 v[116:119], v173 offset:0
    ds_read_b128 v[120:123], v174 offset:0
    ds_read_b128 v[124:127], v175 offset:0
    s_waitcnt lgkmcnt(3)
    v_dot2_f32_bf16 v224, v112, v164, v224
    v_dot2_f32_bf16 v225, v112, v112, v225
    v_dot2_f32_bf16 v226, v113, v164, v226
    v_dot2_f32_bf16 v227, v113, v113, v227
    v_dot2_f32_bf16 v224, v114, v164, v224
    v_dot2_f32_bf16 v225, v114, v114, v225
    v_dot2_f32_bf16 v226, v115, v164, v226
    v_dot2_f32_bf16 v227, v115, v115, v227
    v_permlane32_swap_b32 v112, v114
    v_permlane32_swap_b32 v113, v115
    s_waitcnt lgkmcnt(2)
    v_dot2_f32_bf16 v224, v116, v164, v224
    v_dot2_f32_bf16 v225, v116, v116, v225
    v_dot2_f32_bf16 v226, v117, v164, v226
    v_dot2_f32_bf16 v227, v117, v117, v227
    v_dot2_f32_bf16 v224, v118, v164, v224
    v_dot2_f32_bf16 v225, v118, v118, v225
    v_dot2_f32_bf16 v226, v119, v164, v226
    v_dot2_f32_bf16 v227, v119, v119, v227
    v_permlane32_swap_b32 v116, v118
    v_permlane32_swap_b32 v117, v119
    s_waitcnt lgkmcnt(1)
    v_dot2_f32_bf16 v224, v120, v164, v224
    v_dot2_f32_bf16 v225, v120, v120, v225
    v_dot2_f32_bf16 v226, v121, v164, v226
    v_dot2_f32_bf16 v227, v121, v121, v227
    v_dot2_f32_bf16 v224, v122, v164, v224
    v_dot2_f32_bf16 v225, v122, v122, v225
    v_dot2_f32_bf16 v226, v123, v164, v226
    v_dot2_f32_bf16 v227, v123, v123, v227
    v_permlane32_swap_b32 v120, v122
    v_permlane32_swap_b32 v121, v123
    s_waitcnt lgkmcnt(0)
    v_dot2_f32_bf16 v224, v124, v164, v224
    v_dot2_f32_bf16 v225, v124, v124, v225
    v_dot2_f32_bf16 v226, v125, v164, v226
    v_dot2_f32_bf16 v227, v125, v125, v227
    v_dot2_f32_bf16 v224, v126, v164, v224
    v_dot2_f32_bf16 v225, v126, v126, v225
    v_dot2_f32_bf16 v226, v127, v164, v226
    v_dot2_f32_bf16 v227, v127, v127, v227
    v_permlane32_swap_b32 v124, v126
    v_permlane32_swap_b32 v125, v127
    s_waitcnt vmcnt(4)
    ds_read_b128 v[128:131], v172 offset:4096
    ds_read_b128 v[132:135], v173 offset:4096
    ds_read_b128 v[136:139], v174 offset:4096
    ds_read_b128 v[140:143], v175 offset:4096
    s_waitcnt lgkmcnt(3)
    v_dot2_f32_bf16 v224, v128, v164, v224
    v_dot2_f32_bf16 v225, v128, v128, v225
    v_dot2_f32_bf16 v226, v129, v164, v226
    v_dot2_f32_bf16 v227, v129, v129, v227
    v_dot2_f32_bf16 v224, v130, v164, v224
    v_dot2_f32_bf16 v225, v130, v130, v225
    v_dot2_f32_bf16 v226, v131, v164, v226
    v_dot2_f32_bf16 v227, v131, v131, v227
    v_permlane32_swap_b32 v128, v130
    v_permlane32_swap_b32 v129, v131
    s_waitcnt lgkmcnt(2)
    v_dot2_f32_bf16 v224, v132, v164, v224
    v_dot2_f32_bf16 v225, v132, v132, v225
    v_dot2_f32_bf16 v226, v133, v164, v226
    v_dot2_f32_bf16 v227, v133, v133, v227
    v_dot2_f32_bf16 v224, v134, v164, v224
    v_dot2_f32_bf16 v225, v134, v134, v225
    v_dot2_f32_bf16 v226, v135, v164, v226
    v_dot2_f32_bf16 v227, v135, v135, v227
    v_permlane32_swap_b32 v132, v134
    v_permlane32_swap_b32 v133, v135
    s_waitcnt lgkmcnt(1)
    v_dot2_f32_bf16 v224, v136, v164, v224
    v_dot2_f32_bf16 v225, v136, v136, v225
    v_dot2_f32_bf16 v226, v137, v164, v226
    v_dot2_f32_bf16 v227, v137, v137, v227
    v_dot2_f32_bf16 v224, v138, v164, v224
    v_dot2_f32_bf16 v225, v138, v138, v225
    v_dot2_f32_bf16 v226, v139, v164, v226
    v_dot2_f32_bf16 v227, v139, v139, v227
    v_permlane32_swap_b32 v136, v138
    v_permlane32_swap_b32 v137, v139
    s_waitcnt lgkmcnt(0)
    v_dot2_f32_bf16 v224, v140, v164, v224
    v_dot2_f32_bf16 v225, v140, v140, v225
    v_dot2_f32_bf16 v226, v141, v164, v226
    v_dot2_f32_bf16 v227, v141, v141, v227
    v_dot2_f32_bf16 v224, v142, v164, v224
    v_dot2_f32_bf16 v225, v142, v142, v225
    v_dot2_f32_bf16 v226, v143, v164, v226
    v_dot2_f32_bf16 v227, v143, v143, v227
    v_permlane32_swap_b32 v140, v142
    v_permlane32_swap_b32 v141, v143
    s_waitcnt vmcnt(0)
    ds_read_b128 v[144:147], v172 offset:8192
    ds_read_b128 v[148:151], v173 offset:8192
    ds_read_b128 v[152:155], v174 offset:8192
    ds_read_b128 v[156:159], v175 offset:8192
    s_mov_b64 exec, 1
    ds_add_u32 v166, v9
    s_mov_b64 exec, -1
    s_waitcnt lgkmcnt(4)
    v_dot2_f32_bf16 v224, v144, v164, v224
    v_dot2_f32_bf16 v225, v144, v144, v225
    v_dot2_f32_bf16 v226, v145, v164, v226
    v_dot2_f32_bf16 v227, v145, v145, v227
    v_dot2_f32_bf16 v224, v146, v164, v224
    v_dot2_f32_bf16 v225, v146, v146, v225
    v_dot2_f32_bf16 v226, v147, v164, v226
    v_dot2_f32_bf16 v227, v147, v147, v227
    v_permlane32_swap_b32 v144, v146
    v_permlane32_swap_b32 v145, v147
    s_waitcnt lgkmcnt(3)
    v_dot2_f32_bf16 v224, v148, v164, v224
    v_dot2_f32_bf16 v225, v148, v148, v225
    v_dot2_f32_bf16 v226, v149, v164, v226
    v_dot2_f32_bf16 v227, v149, v149, v227
    v_dot2_f32_bf16 v224, v150, v164, v224
    v_dot2_f32_bf16 v225, v150, v150, v225
    v_dot2_f32_bf16 v226, v151, v164, v226
    v_dot2_f32_bf16 v227, v151, v151, v227
    v_permlane32_swap_b32 v148, v150
    v_permlane32_swap_b32 v149, v151
    s_waitcnt lgkmcnt(2)
    v_dot2_f32_bf16 v224, v152, v164, v224
    v_dot2_f32_bf16 v225, v152, v152, v225
    v_dot2_f32_bf16 v226, v153, v164, v226
    v_dot2_f32_bf16 v227, v153, v153, v227
    v_dot2_f32_bf16 v224, v154, v164, v224
    v_dot2_f32_bf16 v225, v154, v154, v225
    v_dot2_f32_bf16 v226, v155, v164, v226
    v_dot2_f32_bf16 v227, v155, v155, v227
    v_permlane32_swap_b32 v152, v154
    v_permlane32_swap_b32 v153, v155
    s_waitcnt lgkmcnt(1)
    v_dot2_f32_bf16 v224, v156, v164, v224
    v_dot2_f32_bf16 v225, v156, v156, v225
    v_dot2_f32_bf16 v226, v157, v164, v226
    v_dot2_f32_bf16 v227, v157, v157, v227
    v_dot2_f32_bf16 v224, v158, v164, v224
    v_dot2_f32_bf16 v225, v158, v158, v225
    v_dot2_f32_bf16 v226, v159, v164, v226
    v_dot2_f32_bf16 v227, v159, v159, v227
    v_permlane32_swap_b32 v156, v158
    v_permlane32_swap_b32 v157, v159
    s_waitcnt lgkmcnt(0)
    s_mov_b64 s[82:83], 0
    s_branch L_cx
L_cloop:
    s_nop 0
    s_mov_b64 s[82:83], -1
L_cx:
    s_barrier
    s_cmp_eq_u32 s50, 0
    s_cbranch_scc1 L_cx2
    s_mov_b32 s51, 0
L_poll1:
    buffer_load_dword v160, v7, s[8:11], s49 offen offset:0 sc1
    s_add_u32 s51, s51, 1
    s_cmp_gt_u32 s51, 0x40000
    s_cbranch_scc1 L_end
    s_waitcnt vmcnt(0)
    v_cmp_eq_u32 vcc, 0, v160
    s_nop 1
    s_and_b32 s57, vcc_lo, 0x3fff
    s_cbranch_scc1 L_poll1
L_cx2:
    s_and_b32 s52, s45, 1
    s_lshl_b32 s52, s52, 3
    v_add_u32 v5, s52, v18
    v_add_u32 v3, s63, v5
    v_add_u32 v4, s64, v5
    v_add_u32 v5, 114688, v5
    s_add_u32 s72, s48, 0
    s_cmp_eq_u32 s50, 0
    s_cbranch_scc1 L_mk1
    buffer_load_dwordx4 v[48:51], v2, s[8:11], s72 offen offset:0 sc1
    buffer_load_dwordx4 v[52:55], v2, s[8:11], s72 offen offset:1024 sc1
    buffer_load_dwordx4 v[56:59], v2, s[8:11], s72 offen offset:2048 sc1
    buffer_load_dwordx4 v[60:63], v2, s[8:11], s72 offen offset:3072 sc1
    buffer_load_dwordx4 v[64:67], v13, s[8:11], s72 offen offset:0 sc1
    buffer_load_dwordx4 v[68:71], v13, s[8:11], s72 offen offset:1024 sc1
    buffer_load_dwordx4 v[72:75], v13, s[8:11], s72 offen offset:2048 sc1
    buffer_load_dwordx4 v[76:79], v13, s[8:11], s72 offen offset:3072 sc1
L_mk1:
    ds_read_b64_tr_b16 v[208:209], v3 offset:0
    ds_read_b64_tr_b16 v[210:211], v3 offset:512
    ds_read_b64_tr_b16 v[212:213], v3 offset:1024
    ds_read_b64_tr_b16 v[214:215], v3 offset:1536
    ds_read_b64_tr_b16 v[216:217], v3 offset:2048
    ds_read_b64_tr_b16 v[218:219], v3 offset:2560
    ds_read_b64_tr_b16 v[220:221], v3 offset:3072
    ds_read_b64_tr_b16 v[222:223], v3 offset:3584
    s_waitcnt vmcnt(7) lgkmcnt(6)
    v_mfma_f32_32x32x16_bf16 v[160:175], v[208:211], v[48:51], 0
    ds_read_b64_tr_b16 v[208:209], v3 offset:4096
    ds_read_b64_tr_b16 v[210:211], v3 offset:4608
    s_waitcnt lgkmcnt(6)
    v_mfma_f32_32x32x16_bf16 v[176:191], v[48:51], v[212:215], 0
    s_cmp_eq_u32 s50, 0
    s_cbranch_scc1 L_mk2
    s_add_u32 s72, s72, 8192
    buffer_load_dwordx4 v[80:83], v2, s[8:11], s72 offen offset:0 sc1
    buffer_load_dwordx4 v[84:87], v2, s[8:11], s72 offen offset:1024 sc1
L_mk2:
    ds_read_b64_tr_b16 v[212:213], v3 offset:5120
    ds_read_b64_tr_b16 v[214:215], v3 offset:5632
    s_waitcnt vmcnt(8) lgkmcnt(6)
    v_mfma_f32_32x32x16_bf16 v[160:175], v[216:219], v[52:55], v[160:175]
    ds_read_b64_tr_b16 v[216:217], v3 offset:6144
    ds_read_b64_tr_b16 v[218:219], v3 offset:6656
    s_waitcnt lgkmcnt(6)
    v_mfma_f32_32x32x16_bf16 v[176:191], v[52:55], v[220:223], v[176:191]
    ds_read_b64_tr_b16 v[220:221], v3 offset:7168
    ds_read_b64_tr_b16 v[222:223], v3 offset:7680
    s_waitcnt vmcnt(7) lgkmcnt(6)
    v_mfma_f32_32x32x16_bf16 v[160:175], v[208:211], v[56:59], v[160:175]
    ds_read_b64_tr_b16 v[208:209], v3 offset:8192
    ds_read_b64_tr_b16 v[210:211], v3 offset:8704
    s_waitcnt lgkmcnt(6)
    v_mfma_f32_32x32x16_bf16 v[176:191], v[56:59], v[212:215], v[176:191]
    s_cmp_eq_u32 s50, 0
    s_cbranch_scc1 L_mk3
    buffer_load_dwordx4 v[88:91], v2, s[8:11], s72 offen offset:2048 sc1
    buffer_load_dwordx4 v[92:95], v2, s[8:11], s72 offen offset:3072 sc1
L_mk3:
    ds_read_b64_tr_b16 v[212:213], v3 offset:9216
    ds_read_b64_tr_b16 v[214:215], v3 offset:9728
    s_waitcnt vmcnt(8) lgkmcnt(6)
    v_mfma_f32_32x32x16_bf16 v[160:175], v[216:219], v[60:63], v[160:175]
    s_cmp_eq_u32 s50, 0
    s_cbranch_scc1 L_mk4
    s_add_u32 s53, s48, 28672
    buffer_load_dwordx2 v[224:225], v6, s[8:11], s53 offen offset:0 sc1
    buffer_load_dwordx2 v[226:227], v6, s[8:11], s53 offen offset:256 sc1
    buffer_load_dwordx2 v[228:229], v6, s[8:11], s53 offen offset:512 sc1
    buffer_load_dwordx2 v[230:231], v6, s[8:11], s53 offen offset:768 sc1
    buffer_load_dwordx2 v[232:233], v6, s[8:11], s53 offen offset:1024 sc1
    buffer_load_dwordx2 v[234:235], v6, s[8:11], s53 offen offset:1280 sc1
    buffer_load_dwordx2 v[236:237], v6, s[8:11], s53 offen offset:1536 sc1
L_mk4:
    ds_read_b64_tr_b16 v[216:217], v3 offset:10240
    ds_read_b64_tr_b16 v[218:219], v3 offset:10752
    s_waitcnt lgkmcnt(6)
    v_mfma_f32_32x32x16_bf16 v[176:191], v[60:63], v[220:223], v[176:191]
    ds_read_b64_tr_b16 v[220:221], v3 offset:11264
    ds_read_b64_tr_b16 v[222:223], v3 offset:11776
    s_waitcnt vmcnt(14) lgkmcnt(6)
    v_mfma_f32_32x32x16_bf16 v[160:175], v[208:211], v[64:67], v[160:175]
    ds_read_b64_tr_b16 v[208:209], v3 offset:12288
    ds_read_b64_tr_b16 v[210:211], v3 offset:12800
    s_waitcnt lgkmcnt(6)
    v_mfma_f32_32x32x16_bf16 v[176:191], v[64:67], v[212:215], v[176:191]
    s_cmp_eq_u32 s50, 0
    s_cbranch_scc1 L_mk5
    buffer_load_dwordx4 v[96:99], v13, s[8:11], s72 offen offset:0 sc1
    buffer_load_dwordx4 v[100:103], v13, s[8:11], s72 offen offset:1024 sc1
L_mk5:
    ds_read_b64_tr_b16 v[212:213], v3 offset:13312
    ds_read_b64_tr_b16 v[214:215], v3 offset:13824
    s_waitcnt vmcnt(15) lgkmcnt(6)
    v_mfma_f32_32x32x16_bf16 v[160:175], v[216:219], v[68:71], v[160:175]
    ds_read_b64_tr_b16 v[216:217], v3 offset:14336
    ds_read_b64_tr_b16 v[218:219], v3 offset:14848
    s_waitcnt lgkmcnt(6)
    v_mfma_f32_32x32x16_bf16 v[176:191], v[68:71], v[220:223], v[176:191]
    ds_read_b64_tr_b16 v[220:221], v3 offset:15360
    ds_read_b64_tr_b16 v[222:223], v3 offset:15872
    s_waitcnt vmcnt(14) lgkmcnt(6)
    v_mfma_f32_32x32x16_bf16 v[160:175], v[208:211], v[72:75], v[160:175]
    ds_read_b64_tr_b16 v[208:209], v3 offset:16384
    ds_read_b64_tr_b16 v[210:211], v3 offset:16896
    s_waitcnt lgkmcnt(6)
    v_mfma_f32_32x32x16_bf16 v[176:191], v[72:75], v[212:215], v[176:191]
    s_cmp_eq_u32 s50, 0
    s_cbranch_scc1 L_mk6
    buffer_load_dwordx4 v[104:107], v13, s[8:11], s72 offen offset:2048 sc1
    buffer_load_dwordx4 v[108:111], v13, s[8:11], s72 offen offset:3072 sc1
L_mk6:
    ds_read_b64_tr_b16 v[212:213], v3 offset:17408
    ds_read_b64_tr_b16 v[214:215], v3 offset:17920
    s_waitcnt vmcnt(15) lgkmcnt(6)
    v_mfma_f32_32x32x16_bf16 v[160:175], v[216:219], v[76:79], v[160:175]
    ds_read_b64_tr_b16 v[216:217], v3 offset:18432
    ds_read_b64_tr_b16 v[218:219], v3 offset:18944
    s_waitcnt lgkmcnt(6)
    v_mfma_f32_32x32x16_bf16 v[176:191], v[76:79], v[220:223], v[176:191]
    ds_read_b64_tr_b16 v[220:221], v3 offset:19456
    ds_read_b64_tr_b16 v[222:223], v3 offset:19968
    s_waitcnt vmcnt(14) lgkmcnt(6)
    v_mfma_f32_32x32x16_bf16 v[160:175], v[208:211], v[80:83], v[160:175]
    ds_read_b64_tr_b16 v[208:209], v3 offset:20480
    ds_read_b64_tr_b16 v[210:211], v3 offset:20992
    s_waitcnt lgkmcnt(6)
    v_mfma_f32_32x32x16_bf16 v[176:191], v[80:83], v[212:215], v[176:191]
    s_cmp_eq_u32 s50, 0
    s_cbranch_scc1 L_mk7
    s_add_u32 s72, s72, 8192
    buffer_load_dwordx4 v[112:115], v2, s[8:11], s72 offen offset:0 sc1
    buffer_load_dwordx4 v[116:119], v2, s[8:11], s72 offen offset:1024 sc1
L_mk7:
    ds_read_b64_tr_b16 v[212:213], v3 offset:21504
    ds_read_b64_tr_b16 v[214:215], v3 offset:22016
    s_waitcnt vmcnt(15) lgkmcnt(6)
    v_mfma_f32_32x32x16_bf16 v[160:175], v[216:219], v[84:87], v[160:175]
    ds_read_b64_tr_b16 v[216:217], v3 offset:22528
    ds_read_b64_tr_b16 v[218:219], v3 offset:23040
    s_waitcnt lgkmcnt(6)
    v_mfma_f32_32x32x16_bf16 v[176:191], v[84:87], v[220:223], v[176:191]
    ds_read_b64_tr_b16 v[220:221], v3 offset:23552
    ds_read_b64_tr_b16 v[222:223], v3 offset:24064
    s_waitcnt vmcnt(14) lgkmcnt(6)
    v_mfma_f32_32x32x16_bf16 v[160:175], v[208:211], v[88:91], v[160:175]
    s_cmp_eq_u32 s50, 1
    s_cbranch_scc1 L_b0_8
    s_barrier
L_b0_8:
    ds_read_b64_tr_b16 v[208:209], v3 offset:24576
    ds_read_b64_tr_b16 v[210:211], v3 offset:25088
    s_waitcnt lgkmcnt(6)
    v_mfma_f32_32x32x16_bf16 v[176:191], v[88:91], v[212:215], v[176:191]
    s_cmp_eq_u32 s50, 0
    s_cbranch_scc1 L_mk9
    buffer_load_dwordx4 v[120:123], v2, s[8:11], s72 offen offset:2048 sc1
    buffer_load_dwordx4 v[124:127], v2, s[8:11], s72 offen offset:3072 sc1
L_mk9:
    ds_read_b64_tr_b16 v[212:213], v3 offset:25600
    ds_read_b64_tr_b16 v[214:215], v3 offset:26112
    s_waitcnt vmcnt(15) lgkmcnt(6)
    v_mfma_f32_32x32x16_bf16 v[160:175], v[216:219], v[92:95], v[160:175]
    ds_read_b64_tr_b16 v[216:217], v3 offset:26624
    ds_read_b64_tr_b16 v[218:219], v3 offset:27136
    s_waitcnt lgkmcnt(6)
    v_mfma_f32_32x32x16_bf16 v[176:191], v[92:95], v[220:223], v[176:191]
    ds_read_b64_tr_b16 v[220:221], v3 offset:27648
    ds_read_b64_tr_b16 v[222:223], v3 offset:28160
    s_waitcnt vmcnt(7) lgkmcnt(6)
    v_mfma_f32_32x32x16_bf16 v[160:175], v[208:211], v[96:99], v[160:175]
    ds_read_b64_tr_b16 v[208:209], v3 offset:28672
    ds_read_b64_tr_b16 v[210:211], v3 offset:29184
    s_waitcnt lgkmcnt(6)
    v_mfma_f32_32x32x16_bf16 v[176:191], v[96:99], v[212:215], v[176:191]
    s_cmp_eq_u32 s50, 0
    s_cbranch_scc1 L_mk10
    buffer_load_dwordx4 v[128:131], v13, s[8:11], s72 offen offset:0 sc1
    buffer_load_dwordx4 v[132:135], v13, s[8:11], s72 offen offset:1024 sc1
L_mk10:
    ds_read_b64_tr_b16 v[212:213], v3 offset:29696
    ds_read_b64_tr_b16 v[214:215], v3 offset:30208
    s_waitcnt vmcnt(8) lgkmcnt(6)
    v_mfma_f32_32x32x16_bf16 v[160:175], v[216:219], v[100:103], v[160:175]
    ds_read_b64_tr_b16 v[216:217], v3 offset:30720
    ds_read_b64_tr_b16 v[218:219], v3 offset:31232
    s_waitcnt lgkmcnt(6)
    v_mfma_f32_32x32x16_bf16 v[176:191], v[100:103], v[220:223], v[176:191]
    ds_read_b64_tr_b16 v[220:221], v3 offset:31744
    ds_read_b64_tr_b16 v[222:223], v3 offset:32256
    s_waitcnt vmcnt(7) lgkmcnt(6)
    v_mfma_f32_32x32x16_bf16 v[160:175], v[208:211], v[104:107], v[160:175]
    ds_read_b64_tr_b16 v[208:209], v3 offset:32768
    ds_read_b64_tr_b16 v[210:211], v3 offset:33280
    s_waitcnt lgkmcnt(6)
    v_mfma_f32_32x32x16_bf16 v[176:191], v[104:107], v[212:215], v[176:191]
    s_cmp_eq_u32 s50, 0
    s_cbranch_scc1 L_mk11
    buffer_load_dwordx4 v[136:139], v13, s[8:11], s72 offen offset:2048 sc1
    buffer_load_dwordx4 v[140:143], v13, s[8:11], s72 offen offset:3072 sc1
L_mk11:
    ds_read_b64_tr_b16 v[212:213], v3 offset:33792
    ds_read_b64_tr_b16 v[214:215], v3 offset:34304
    s_waitcnt vmcnt(8) lgkmcnt(6)
    v_mfma_f32_32x32x16_bf16 v[160:175], v[216:219], v[108:111], v[160:175]
    v_add_f32 v224, v224, v226
    v_add_f32 v225, v225, v227
    ds_read_b64_tr_b16 v[216:217], v3 offset:34816
    ds_read_b64_tr_b16 v[218:219], v3 offset:35328
    s_waitcnt lgkmcnt(6)
    v_mfma_f32_32x32x16_bf16 v[176:191], v[108:111], v[220:223], v[176:191]
    v_add_f32 v224, v224, v228
    v_add_f32 v225, v225, v229
    ds_read_b64_tr_b16 v[220:221], v3 offset:35840
    ds_read_b64_tr_b16 v[222:223], v3 offset:36352
    s_waitcnt vmcnt(7) lgkmcnt(6)
    v_mfma_f32_32x32x16_bf16 v[160:175], v[208:211], v[112:115], v[160:175]
    v_add_f32 v224, v224, v230
    v_add_f32 v225, v225, v231
    ds_read_b64_tr_b16 v[208:209], v3 offset:36864
    ds_read_b64_tr_b16 v[210:211], v3 offset:37376
    s_waitcnt lgkmcnt(6)
    v_mfma_f32_32x32x16_bf16 v[176:191], v[112:115], v[212:215], v[176:191]
    s_cmp_eq_u32 s50, 0
    s_cbranch_scc1 L_mk12
    s_add_u32 s72, s72, 8192
    buffer_load_dwordx4 v[144:147], v2, s[8:11], s72 offen offset:0 sc1
    buffer_load_dwordx4 v[148:151], v2, s[8:11], s72 offen offset:1024 sc1
L_mk12:
    v_add_f32 v224, v224, v232
    v_add_f32 v225, v225, v233
    ds_read_b64_tr_b16 v[212:213], v3 offset:37888
    ds_read_b64_tr_b16 v[214:215], v3 offset:38400
    s_waitcnt vmcnt(8) lgkmcnt(6)
    v_mfma_f32_32x32x16_bf16 v[160:175], v[216:219], v[116:119], v[160:175]
    v_add_f32 v224, v224, v234
    v_add_f32 v225, v225, v235
    ds_read_b64_tr_b16 v[216:217], v3 offset:38912
    ds_read_b64_tr_b16 v[218:219], v3 offset:39424
    s_waitcnt lgkmcnt(6)
    v_mfma_f32_32x32x16_bf16 v[176:191], v[116:119], v[220:223], v[176:191]
    v_add_f32 v224, v224, v236
    v_add_f32 v225, v225, v237
    ds_read_b64_tr_b16 v[220:221], v3 offset:39936
    ds_read_b64_tr_b16 v[222:223], v3 offset:40448
    s_waitcnt vmcnt(7) lgkmcnt(6)
    v_mfma_f32_32x32x16_bf16 v[160:175], v[208:211], v[120:123], v[160:175]
    v_mov_b32 v226, v224
    s_nop 1
    v_permlane32_swap_b32 v224, v226
    ds_read_b64_tr_b16 v[208:209], v3 offset:40960
    ds_read_b64_tr_b16 v[210:211], v3 offset:41472
    s_waitcnt lgkmcnt(6)
    v_mfma_f32_32x32x16_bf16 v[176:191], v[120:123], v[212:215], v[176:191]
    s_cmp_eq_u32 s50, 0
    s_cbranch_scc1 L_mk13
    buffer_load_dwordx4 v[152:155], v2, s[8:11], s72 offen offset:2048 sc1
    buffer_load_dwordx4 v[156:159], v2, s[8:11], s72 offen offset:3072 sc1
L_mk13:
    v_add_f32 v224, v224, v226
    v_mov_b32 v227, v225
    ds_read_b64_tr_b16 v[212:213], v3 offset:41984
    ds_read_b64_tr_b16 v[214:215], v3 offset:42496
    s_waitcnt vmcnt(8) lgkmcnt(6)
    v_mfma_f32_32x32x16_bf16 v[160:175], v[216:219], v[124:127], v[160:175]
    v_permlane32_swap_b32 v225, v227
    v_add_f32 v225, v225, v227
    ds_read_b64_tr_b16 v[216:217], v3 offset:43008
    ds_read_b64_tr_b16 v[218:219], v3 offset:43520
    s_waitcnt lgkmcnt(6)
    v_mfma_f32_32x32x16_bf16 v[176:191], v[124:127], v[220:223], v[176:191]
    v_mul_f32 v229, 0xbb124925, v224
    v_mul_f32 v225, 0x3b124925, v225
    ds_read_b64_tr_b16 v[220:221], v3 offset:44032
    ds_read_b64_tr_b16 v[222:223], v3 offset:44544
    s_waitcnt vmcnt(7) lgkmcnt(6)
    v_mfma_f32_32x32x16_bf16 v[160:175], v[208:211], v[128:131], v[160:175]
    v_fma_f32 v225, v229, -v229, v225
    v_max_f32 v225, 0, v225
    ds_read_b64_tr_b16 v[208:209], v3 offset:45056
    ds_read_b64_tr_b16 v[210:211], v3 offset:45568
    s_waitcnt lgkmcnt(6)
    v_mfma_f32_32x32x16_bf16 v[176:191], v[128:131], v[212:215], v[176:191]
    v_add_f32 v226, 0x3727c5ac, v225
    v_rsq_f32 v8, v226
    ds_read_b64_tr_b16 v[212:213], v3 offset:46080
    ds_read_b64_tr_b16 v[214:215], v3 offset:46592
    s_waitcnt vmcnt(6) lgkmcnt(6)
    v_mfma_f32_32x32x16_bf16 v[160:175], v[216:219], v[132:135], v[160:175]
    v_cvt_pk_bf16_f32 v20, v229, v229
    v_lshlrev_b32 v224, 16, v20
    ds_read_b64_tr_b16 v[216:217], v3 offset:47104
    ds_read_b64_tr_b16 v[218:219], v3 offset:47616
    s_waitcnt lgkmcnt(6)
    v_mfma_f32_32x32x16_bf16 v[176:191], v[132:135], v[220:223], v[176:191]
    v_sub_f32 v224, v229, v224
    v_cvt_pk_bf16_f32 v21, v224, v224
    ds_read_b64_tr_b16 v[220:221], v3 offset:48128
    ds_read_b64_tr_b16 v[222:223], v3 offset:48640
    s_waitcnt vmcnt(5) lgkmcnt(6)
    v_mfma_f32_32x32x16_bf16 v[160:175], v[208:211], v[136:139], v[160:175]
    v_mov_b32 v22, 0
    v_mov_b32 v23, 0
    ds_read_b64_tr_b16 v[208:209], v3 offset:49152
    ds_read_b64_tr_b16 v[210:211], v3 offset:49664
    s_waitcnt lgkmcnt(6)
    v_mfma_f32_32x32x16_bf16 v[176:191], v[136:139], v[212:215], v[176:191]
    s_mov_b32 s58, 0
    s_mov_b32 s59, -1
    ds_read_b64_tr_b16 v[212:213], v3 offset:50176
    ds_read_b64_tr_b16 v[214:215], v3 offset:50688
    s_waitcnt vmcnt(4) lgkmcnt(6)
    v_mfma_f32_32x32x16_bf16 v[160:175], v[216:219], v[140:143], v[160:175]
    s_mov_b64 exec, s[58:59]
    v_mov_b32 v20, 0
    v_mov_b32 v21, 0
    v_mov_b32 v22, 0
    v_mov_b32 v23, 0
    s_mov_b64 exec, -1
    ds_read_b64_tr_b16 v[216:217], v3 offset:51200
    ds_read_b64_tr_b16 v[218:219], v3 offset:51712
    s_waitcnt lgkmcnt(6)
    v_mfma_f32_32x32x16_bf16 v[176:191], v[140:143], v[220:223], v[176:191]
    s_lshl_b32 s52, s46, 7
    s_add_u32 s52, s52, 114688
    ds_read_b64_tr_b16 v[220:221], v3 offset:52224
    ds_read_b64_tr_b16 v[222:223], v3 offset:52736
    s_waitcnt vmcnt(3) lgkmcnt(6)
    v_mfma_f32_32x32x16_bf16 v[160:175], v[208:211], v[144:147], v[160:175]
    v_and_b32 v224, 31, v1
    v_lshl_add_u32 v224, v224, 2, s52
    ds_read_b64_tr_b16 v[208:209], v3 offset:53248
    ds_read_b64_tr_b16 v[210:211], v3 offset:53760
    s_waitcnt lgkmcnt(6)
    v_mfma_f32_32x32x16_bf16 v[176:191], v[144:147], v[212:215], v[176:191]
    ds_write_b32 v224, v8
    v_lshrrev_b32 v225, 5, v1
    ds_read_b64_tr_b16 v[212:213], v3 offset:54272
    ds_read_b64_tr_b16 v[214:215], v3 offset:54784
    s_waitcnt vmcnt(2) lgkmcnt(7)
    v_mfma_f32_32x32x16_bf16 v[160:175], v[216:219], v[148:151], v[160:175]
    v_lshl_add_u32 v225, v225, 4, s52
    ds_read_b128 v[192:195], v225 offset:0
    ds_read_b64_tr_b16 v[216:217], v3 offset:55296
    ds_read_b64_tr_b16 v[218:219], v3 offset:55808
    s_waitcnt lgkmcnt(8)
    v_mfma_f32_32x32x16_bf16 v[176:191], v[148:151], v[220:223], v[176:191]
    ds_read_b128 v[196:199], v225 offset:32
    ds_read_b128 v[200:203], v225 offset:64
    ds_read_b64_tr_b16 v[220:221], v3 offset:56320
    ds_read_b64_tr_b16 v[222:223], v3 offset:56832
    s_waitcnt vmcnt(1) lgkmcnt(10)
    v_mfma_f32_32x32x16_bf16 v[160:175], v[208:211], v[152:155], v[160:175]
    ds_read_b128 v[204:207], v225 offset:96
    ds_read_b64_tr_b16 v[208:209], v5 offset:16384
    ds_read_b64_tr_b16 v[210:211], v5 offset:16896
    s_waitcnt lgkmcnt(10)
    v_mfma_f32_32x32x16_bf16 v[176:191], v[152:155], v[212:215], v[176:191]
    ds_read_b64_tr_b16 v[212:213], v5 offset:16640
    ds_read_b64_tr_b16 v[214:215], v5 offset:17152
    s_waitcnt vmcnt(0) lgkmcnt(9)
    v_mfma_f32_32x32x16_bf16 v[160:175], v[216:219], v[156:159], v[160:175]
    s_waitcnt lgkmcnt(5)
    v_mfma_f32_32x32x16_bf16 v[176:191], v[156:159], v[220:223], v[176:191]
    s_waitcnt lgkmcnt(2)
    v_mfma_f32_32x32x16_bf16 v[160:175], v[208:211], v[20:23], v[160:175]
    s_waitcnt lgkmcnt(0)
    v_mfma_f32_32x32x16_bf16 v[176:191], v[20:23], v[212:215], v[176:191]
    s_nop 9
    v_mul_f32 v160, v160, v8
    v_mul_f32 v161, v161, v8
    v_mul_f32 v162, v162, v8
    v_mul_f32 v163, v163, v8
    v_mul_f32 v164, v164, v8
    v_mul_f32 v165, v165, v8
    v_mul_f32 v166, v166, v8
    v_mul_f32 v167, v167, v8
    v_mul_f32 v168, v168, v8
    v_mul_f32 v169, v169, v8
    v_mul_f32 v170, v170, v8
    v_mul_f32 v171, v171, v8
    v_mul_f32 v172, v172, v8
    v_mul_f32 v173, v173, v8
    v_mul_f32 v174, v174, v8
    v_mul_f32 v175, v175, v8
    v_cvt_pk_bf16_f32 v224, v160, v161
    v_cvt_pk_bf16_f32 v225, v162, v163
    v_cvt_pk_bf16_f32 v226, v164, v165
    v_cvt_pk_bf16_f32 v227, v166, v167
    v_cvt_pk_bf16_f32 v228, v168, v169
    v_cvt_pk_bf16_f32 v229, v170, v171
    v_cvt_pk_bf16_f32 v230, v172, v173
    v_cvt_pk_bf16_f32 v231, v174, v175
    s_mov_b32 s58, 0
    s_mov_b32 s59, -1
    s_mov_b64 exec, s[58:59]
    v_mov_b32 v230, 0
    v_mov_b32 v231, 0
    s_mov_b64 exec, -1
    buffer_store_dwordx4 v[224:227], v2, s[8:11], s65 offen offset:0 sc1
    buffer_store_dwordx4 v[228:231], v2, s[8:11], s65 offen offset:1024 sc1
    v_mul_f32 v176, v176, v192
    v_mul_f32 v177, v177, v193
    v_mul_f32 v178, v178, v194
    v_mul_f32 v179, v179, v195
    v_mul_f32 v180, v180, v196
    v_mul_f32 v181, v181, v197
    v_mul_f32 v182, v182, v198
    v_mul_f32 v183, v183, v199
    v_mul_f32 v184, v184, v200
    v_mul_f32 v185, v185, v201
    v_mul_f32 v186, v186, v202
    v_mul_f32 v187, v187, v203
    v_mul_f32 v188, v188, v204
    v_mul_f32 v189, v189, v205
    v_mul_f32 v190, v190, v206
    v_mul_f32 v191, v191, v207
    v_cvt_pk_bf16_f32 v232, v176, v177
    v_cvt_pk_bf16_f32 v233, v178, v179
    v_cvt_pk_bf16_f32 v234, v180, v181
    v_cvt_pk_bf16_f32 v235, v182, v183
    v_cvt_pk_bf16_f32 v236, v184, v185
    v_cvt_pk_bf16_f32 v237, v186, v187
    v_cvt_pk_bf16_f32 v238, v188, v189
    v_cvt_pk_bf16_f32 v239, v190, v191
    s_mov_b32 s58, 0x10000000
    s_mov_b32 s59, 0x10000000
    s_mov_b64 exec, s[58:59]
    v_mov_b32 v232, 0x3f803f80
    v_mov_b32 v233, 0x3f803f80
    v_mov_b32 v234, 0x3f803f80
    v_mov_b32 v235, 0x3f803f80
    v_mov_b32 v236, 0x3f803f80
    v_mov_b32 v237, 0x3f803f80
    v_mov_b32 v238, 0x3f803f80
    v_mov_b32 v239, 0x3f803f80
    s_mov_b32 s58, 0xe0000000
    s_mov_b32 s59, 0xe0000000
    s_mov_b64 exec, s[58:59]
    v_mov_b32 v232, 0
    v_mov_b32 v233, 0
    v_mov_b32 v234, 0
    v_mov_b32 v235, 0
    v_mov_b32 v236, 0
    v_mov_b32 v237, 0
    v_mov_b32 v238, 0
    v_mov_b32 v239, 0
    s_mov_b64 exec, -1
    buffer_store_dwordx4 v[232:235], v2, s[8:11], s65 offen offset:2048 sc1
    buffer_store_dwordx4 v[236:239], v2, s[8:11], s65 offen offset:3072 sc1
    s_mul_i32 s53, s45, 72
    s_add_u32 s53, s53, s47
    s_lshl_b32 s53, s53, 7
    s_lshl_b32 s54, s47, 9
    s_sub_u32 s54, s49, s54
    s_add_u32 s54, s54, s53
    s_add_u32 s54, s54, 33284
    v_mul_u32_u24 v255, 508, v1
    s_waitcnt vmcnt(0)
    s_mov_b64 exec, 3
    buffer_store_dword v9, v255, s[8:11], s54 offen sc1
    s_mov_b64 exec, -1
    s_barrier
    s_lshl_b32 s52, s46, 12
    s_add_u32 s52, s52, s63
    v_add_u32 v252, s52, v2
    ds_write_b128 v252, v[224:227] offset:32768
    ds_write_b128 v252, v[228:231] offset:33792
    ds_write_b128 v252, v[232:235] offset:34816
    ds_write_b128 v252, v[236:239] offset:35840
    ds_read_b64_tr_b16 v[208:209], v4 offset:0
    ds_read_b64_tr_b16 v[210:211], v4 offset:512
    ds_read_b64_tr_b16 v[212:213], v4 offset:1024
    ds_read_b64_tr_b16 v[214:215], v4 offset:1536
    ds_read_b64_tr_b16 v[216:217], v4 offset:2048
    ds_read_b64_tr_b16 v[218:219], v4 offset:2560
    ds_read_b64_tr_b16 v[220:221], v4 offset:3072
    ds_read_b64_tr_b16 v[222:223], v4 offset:3584
    s_waitcnt lgkmcnt(6)
    v_mfma_f32_32x32x16_bf16 v[192:207], v[208:211], v[48:51], 0
    ds_read_b64_tr_b16 v[208:209], v4 offset:4096
    ds_read_b64_tr_b16 v[210:211], v4 offset:4608
    s_waitcnt lgkmcnt(6)
    v_mfma_f32_32x32x16_bf16 v[192:207], v[212:215], v[52:55], v[192:207]
    ds_read_b64_tr_b16 v[212:213], v4 offset:5120
    ds_read_b64_tr_b16 v[214:215], v4 offset:5632
    s_waitcnt lgkmcnt(6)
    v_mfma_f32_32x32x16_bf16 v[192:207], v[216:219], v[56:59], v[192:207]
    ds_read_b64_tr_b16 v[216:217], v4 offset:6144
    ds_read_b64_tr_b16 v[218:219], v4 offset:6656
    s_waitcnt lgkmcnt(6)
    v_mfma_f32_32x32x16_bf16 v[192:207], v[220:223], v[60:63], v[192:207]
    ds_read_b64_tr_b16 v[220:221], v4 offset:7168
    ds_read_b64_tr_b16 v[222:223], v4 offset:7680
    s_waitcnt lgkmcnt(6)
    v_mfma_f32_32x32x16_bf16 v[192:207], v[208:211], v[64:67], v[192:207]
    ds_read_b64_tr_b16 v[208:209], v4 offset:8192
    ds_read_b64_tr_b16 v[210:211], v4 offset:8704
    s_waitcnt lgkmcnt(6)
    v_mfma_f32_32x32x16_bf16 v[192:207], v[212:215], v[68:71], v[192:207]
    ds_read_b64_tr_b16 v[212:213], v4 offset:9216
    ds_read_b64_tr_b16 v[214:215], v4 offset:9728
    s_waitcnt lgkmcnt(6)
    v_mfma_f32_32x32x16_bf16 v[192:207], v[216:219], v[72:75], v[192:207]
    ds_read_b64_tr_b16 v[216:217], v4 offset:10240
    ds_read_b64_tr_b16 v[218:219], v4 offset:10752
    s_waitcnt lgkmcnt(6)
    v_mfma_f32_32x32x16_bf16 v[192:207], v[220:223], v[76:79], v[192:207]
    ds_read_b64_tr_b16 v[220:221], v4 offset:11264
    ds_read_b64_tr_b16 v[222:223], v4 offset:11776
    s_waitcnt lgkmcnt(6)
    v_mfma_f32_32x32x16_bf16 v[192:207], v[208:211], v[80:83], v[192:207]
    ds_read_b64_tr_b16 v[208:209], v4 offset:12288
    ds_read_b64_tr_b16 v[210:211], v4 offset:12800
    s_waitcnt lgkmcnt(6)
    v_mfma_f32_32x32x16_bf16 v[192:207], v[212:215], v[84:87], v[192:207]
    ds_read_b64_tr_b16 v[212:213], v4 offset:13312
    ds_read_b64_tr_b16 v[214:215], v4 offset:13824
    s_waitcnt lgkmcnt(6)
    v_mfma_f32_32x32x16_bf16 v[192:207], v[216:219], v[88:91], v[192:207]
    ds_read_b64_tr_b16 v[216:217], v4 offset:14336
    ds_read_b64_tr_b16 v[218:219], v4 offset:14848
    s_waitcnt lgkmcnt(6)
    v_mfma_f32_32x32x16_bf16 v[192:207], v[220:223], v[92:95], v[192:207]
    ds_read_b64_tr_b16 v[220:221], v4 offset:15360
    ds_read_b64_tr_b16 v[222:223], v4 offset:15872
    s_waitcnt lgkmcnt(6)
    v_mfma_f32_32x32x16_bf16 v[192:207], v[208:211], v[96:99], v[192:207]
    ds_read_b64_tr_b16 v[208:209], v4 offset:16384
    ds_read_b64_tr_b16 v[210:211], v4 offset:16896
    s_waitcnt lgkmcnt(6)
    v_mfma_f32_32x32x16_bf16 v[192:207], v[212:215], v[100:103], v[192:207]
    ds_read_b64_tr_b16 v[212:213], v4 offset:17408
    ds_read_b64_tr_b16 v[214:215], v4 offset:17920
    s_waitcnt lgkmcnt(6)
    v_mfma_f32_32x32x16_bf16 v[192:207], v[216:219], v[104:107], v[192:207]
    ds_read_b64_tr_b16 v[216:217], v4 offset:18432
    ds_read_b64_tr_b16 v[218:219], v4 offset:18944
    s_waitcnt lgkmcnt(6)
    v_mfma_f32_32x32x16_bf16 v[192:207], v[220:223], v[108:111], v[192:207]
    ds_read_b64_tr_b16 v[220:221], v4 offset:19456
    ds_read_b64_tr_b16 v[222:223], v4 offset:19968
    s_waitcnt lgkmcnt(6)
    v_mfma_f32_32x32x16_bf16 v[192:207], v[208:211], v[112:115], v[192:207]
    ds_read_b64_tr_b16 v[208:209], v4 offset:20480
    ds_read_b64_tr_b16 v[210:211], v4 offset:20992
    s_waitcnt lgkmcnt(6)
    v_mfma_f32_32x32x16_bf16 v[192:207], v[212:215], v[116:119], v[192:207]
    ds_read_b64_tr_b16 v[212:213], v4 offset:21504
    ds_read_b64_tr_b16 v[214:215], v4 offset:22016
    s_waitcnt lgkmcnt(6)
    v_mfma_f32_32x32x16_bf16 v[192:207], v[216:219], v[120:123], v[192:207]
    ds_read_b64_tr_b16 v[216:217], v4 offset:22528
    ds_read_b64_tr_b16 v[218:219], v4 offset:23040
    s_waitcnt lgkmcnt(6)
    v_mfma_f32_32x32x16_bf16 v[192:207], v[220:223], v[124:127], v[192:207]
    ds_read_b64_tr_b16 v[220:221], v4 offset:23552
    ds_read_b64_tr_b16 v[222:223], v4 offset:24064
    s_waitcnt lgkmcnt(6)
    v_mfma_f32_32x32x16_bf16 v[192:207], v[208:211], v[128:131], v[192:207]
    ds_read_b64_tr_b16 v[208:209], v4 offset:24576
    ds_read_b64_tr_b16 v[210:211], v4 offset:25088
    s_waitcnt lgkmcnt(6)
    v_mfma_f32_32x32x16_bf16 v[192:207], v[212:215], v[132:135], v[192:207]
    ds_read_b64_tr_b16 v[212:213], v4 offset:25600
    ds_read_b64_tr_b16 v[214:215], v4 offset:26112
    s_waitcnt lgkmcnt(6)
    v_mfma_f32_32x32x16_bf16 v[192:207], v[216:219], v[136:139], v[192:207]
    ds_read_b64_tr_b16 v[216:217], v4 offset:26624
    ds_read_b64_tr_b16 v[218:219], v4 offset:27136
    s_waitcnt lgkmcnt(6)
    v_mfma_f32_32x32x16_bf16 v[192:207], v[220:223], v[140:143], v[192:207]
    s_cmp_eq_u32 s50, 1
    s_cbranch_scc1 L_b0_14
    s_barrier
L_b0_14:
    ds_read_b64_tr_b16 v[220:221], v4 offset:27648
    ds_read_b64_tr_b16 v[222:223], v4 offset:28160
    s_waitcnt lgkmcnt(6)
    v_mfma_f32_32x32x16_bf16 v[192:207], v[208:211], v[144:147], v[192:207]
    ds_read_b64_tr_b16 v[208:209], v5 offset:17408
    ds_read_b64_tr_b16 v[210:211], v5 offset:17920
    s_waitcnt lgkmcnt(6)
    v_mfma_f32_32x32x16_bf16 v[192:207], v[212:215], v[148:151], v[192:207]
    s_waitcnt lgkmcnt(4)
    v_mfma_f32_32x32x16_bf16 v[192:207], v[216:219], v[152:155], v[192:207]
    s_waitcnt lgkmcnt(2)
    v_mfma_f32_32x32x16_bf16 v[192:207], v[220:223], v[156:159], v[192:207]
    s_waitcnt lgkmcnt(0)
    v_mfma_f32_32x32x16_bf16 v[192:207], v[208:211], v[20:23], v[192:207]
    v_mul_f32 v160, 0x3e8b97f6, v8
    s_nop 10
    v_mul_f32 v192, v192, v160
    v_mul_f32 v193, v193, v160
    v_mul_f32 v194, v194, v160
    v_mul_f32 v195, v195, v160
    v_mul_f32 v196, v196, v160
    v_mul_f32 v197, v197, v160
    v_mul_f32 v198, v198, v160
    v_mul_f32 v199, v199, v160
    v_mul_f32 v200, v200, v160
    v_mul_f32 v201, v201, v160
    v_mul_f32 v202, v202, v160
    v_mul_f32 v203, v203, v160
    v_mul_f32 v204, v204, v160
    v_mul_f32 v205, v205, v160
    v_mul_f32 v206, v206, v160
    v_mul_f32 v207, v207, v160
    v_cvt_pk_bf16_f32 v244, v192, v193
    v_cvt_pk_bf16_f32 v245, v194, v195
    v_cvt_pk_bf16_f32 v246, v196, v197
    v_cvt_pk_bf16_f32 v247, v198, v199
    v_cvt_pk_bf16_f32 v248, v200, v201
    v_cvt_pk_bf16_f32 v249, v202, v203
    v_cvt_pk_bf16_f32 v250, v204, v205
    v_cvt_pk_bf16_f32 v251, v206, v207
    s_mov_b32 s58, 0
    s_mov_b32 s59, -1
    s_mov_b64 exec, s[58:59]
    v_mov_b32 v250, 0x3f80
    v_mov_b32 v251, 0
    s_mov_b64 exec, -1
    s_barrier
    v_mov_b32 v254, 132544
    ds_read_b32 v253, v254
    s_waitcnt lgkmcnt(0)
    v_readfirstlane_b32 s61, v253
    s_nop 1
    s_sub_u32 s61, s61, 1
    ds_read_b128 v[208:211], v252 offset:32768
    ds_read_b128 v[212:215], v252 offset:33792
    v_mov_b32 v236, 0
    v_mov_b32 v237, 0
    v_mov_b32 v238, 0
    v_mov_b32 v239, 0
    v_mov_b32 v242, 0
    v_mov_b32 v243, 0
    s_mov_b64 exec, 0xffffffff
    v_mov_b32 v236, 0xbf80bf80
    v_mov_b32 v237, 0xbf80
    s_mov_b64 exec, -1
    ds_read_b128 v[216:219], v252 offset:0
    ds_read_b128 v[220:223], v252 offset:1024
    s_waitcnt lgkmcnt(3)
    v_mfma_f32_32x32x16_bf16 v[48:63], v[208:211], v[244:247], 0
    s_waitcnt lgkmcnt(2)
    v_mfma_f32_32x32x16_bf16 v[48:63], v[212:215], v[248:251], v[48:63]
    ds_read_b128 v[208:211], v252 offset:28672
    ds_read_b128 v[212:215], v252 offset:29696
    s_waitcnt lgkmcnt(3)
    v_mfma_f32_32x32x16_bf16 v[64:79], v[216:219], v[244:247], 0
    s_waitcnt lgkmcnt(2)
    v_mfma_f32_32x32x16_bf16 v[64:79], v[220:223], v[248:251], v[64:79]
    ds_read_b128 v[216:219], v252 offset:24576
    ds_read_b128 v[220:223], v252 offset:25600
    s_waitcnt lgkmcnt(3)
    v_mfma_f32_32x32x16_bf16 v[80:95], v[208:211], v[244:247], 0
    s_waitcnt lgkmcnt(2)
    v_mfma_f32_32x32x16_bf16 v[80:95], v[212:215], v[248:251], v[80:95]
    ds_read_b128 v[208:211], v252 offset:20480
    ds_read_b128 v[212:215], v252 offset:21504
    s_waitcnt lgkmcnt(3)
    v_mfma_f32_32x32x16_bf16 v[96:111], v[216:219], v[244:247], 0
    v_cmp_le_i32 vcc, 0, v11
    v_cmp_le_i32 s[58:59], 1, v11
    s_nop 0
    v_cndmask_b32 v48, v12, v48, vcc
    v_cndmask_b32 v64, v64, v12, vcc
    v_cmp_le_i32 vcc, 2, v11
    v_cndmask_b32 v49, v12, v49, s[58:59]
    v_cndmask_b32 v65, v65, v12, s[58:59]
    v_cmp_le_i32 s[58:59], 3, v11
    v_cndmask_b32 v50, v12, v50, vcc
    v_cndmask_b32 v66, v66, v12, vcc
    v_cmp_le_i32 vcc, 8, v11
    v_cndmask_b32 v51, v12, v51, s[58:59]
    s_waitcnt lgkmcnt(2)
    v_mfma_f32_32x32x16_bf16 v[96:111], v[220:223], v[248:251], v[96:111]
    v_cndmask_b32 v67, v67, v12, s[58:59]
    v_cmp_le_i32 s[58:59], 9, v11
    v_cndmask_b32 v52, v12, v52, vcc
    v_cndmask_b32 v68, v68, v12, vcc
    v_cmp_le_i32 vcc, 10, v11
    v_cndmask_b32 v53, v12, v53, s[58:59]
    v_cndmask_b32 v69, v69, v12, s[58:59]
    v_cmp_le_i32 s[58:59], 11, v11
    v_cndmask_b32 v54, v12, v54, vcc
    v_cndmask_b32 v70, v70, v12, vcc
    v_cmp_le_i32 vcc, 16, v11
    v_cndmask_b32 v55, v12, v55, s[58:59]
    ds_read_b128 v[216:219], v252 offset:16384
    ds_read_b128 v[220:223], v252 offset:17408
    s_waitcnt lgkmcnt(3)
    v_mfma_f32_32x32x16_bf16 v[112:127], v[208:211], v[244:247], 0
    v_cndmask_b32 v71, v71, v12, s[58:59]
    v_cmp_le_i32 s[58:59], 17, v11
    v_cndmask_b32 v56, v12, v56, vcc
    v_cndmask_b32 v72, v72, v12, vcc
    v_cmp_le_i32 vcc, 18, v11
    v_cndmask_b32 v57, v12, v57, s[58:59]
    v_cndmask_b32 v73, v73, v12, s[58:59]
    v_cmp_le_i32 s[58:59], 19, v11
    v_cndmask_b32 v58, v12, v58, vcc
    v_cndmask_b32 v74, v74, v12, vcc
    v_cmp_le_i32 vcc, 24, v11
    v_cndmask_b32 v59, v12, v59, s[58:59]
    s_waitcnt lgkmcnt(2)
    v_mfma_f32_32x32x16_bf16 v[112:127], v[212:215], v[248:251], v[112:127]
    v_cndmask_b32 v75, v75, v12, s[58:59]
    v_cmp_le_i32 s[58:59], 25, v11
    v_cndmask_b32 v60, v12, v60, vcc
    v_cndmask_b32 v76, v76, v12, vcc
    v_cmp_le_i32 vcc, 26, v11
    v_cndmask_b32 v61, v12, v61, s[58:59]
    v_cndmask_b32 v77, v77, v12, s[58:59]
    v_cmp_le_i32 s[58:59], 27, v11
    v_cndmask_b32 v62, v12, v62, vcc
    v_cndmask_b32 v78, v78, v12, vcc
    v_cndmask_b32 v63, v12, v63, s[58:59]
    v_cndmask_b32 v79, v79, v12, s[58:59]
    ds_read_b128 v[208:211], v252 offset:12288
    ds_read_b128 v[212:215], v252 offset:13312
    s_waitcnt lgkmcnt(3)
    v_mfma_f32_32x32x16_bf16 v[128:143], v[216:219], v[244:247], 0
    v_max3_f32 v226, v80, v81, v82
    v_max3_f32 v227, v96, v97, v98
    v_max3_f32 v226, v226, v83, v84
    v_max3_f32 v227, v227, v99, v100
    v_max3_f32 v226, v226, v85, v86
    v_max3_f32 v227, v227, v101, v102
    v_max3_f32 v226, v226, v87, v88
    v_max3_f32 v227, v227, v103, v104
    s_waitcnt lgkmcnt(2)
    v_mfma_f32_32x32x16_bf16 v[128:143], v[220:223], v[248:251], v[128:143]
    v_max3_f32 v226, v226, v89, v90
    v_max3_f32 v227, v227, v105, v106
    v_max3_f32 v226, v226, v91, v92
    v_max3_f32 v227, v227, v107, v108
    v_max3_f32 v226, v226, v93, v94
    v_max3_f32 v227, v227, v109, v110
    v_max_f32 v226, v226, v95
    v_max_f32 v227, v227, v111
    ds_read_b128 v[216:219], v252 offset:8192
    ds_read_b128 v[220:223], v252 offset:9216
    s_waitcnt lgkmcnt(3)
    v_mfma_f32_32x32x16_bf16 v[144:159], v[208:211], v[244:247], 0
    v_max3_f32 v224, v48, v49, v50
    v_max3_f32 v225, v64, v65, v66
    v_max3_f32 v224, v224, v51, v52
    v_max3_f32 v225, v225, v67, v68
    v_max3_f32 v224, v224, v53, v54
    v_max3_f32 v225, v225, v69, v70
    v_max3_f32 v224, v224, v55, v56
    v_max3_f32 v225, v225, v71, v72
    s_waitcnt lgkmcnt(2)
    v_mfma_f32_32x32x16_bf16 v[144:159], v[212:215], v[248:251], v[144:159]
    v_max3_f32 v224, v224, v57, v58
    v_max3_f32 v225, v225, v73, v74
    v_max3_f32 v224, v224, v59, v60
    v_max3_f32 v225, v225, v75, v76
    v_max3_f32 v224, v224, v61, v62
    v_max3_f32 v225, v225, v77, v78
    v_max_f32 v224, v224, v63
    v_max_f32 v225, v225, v79
    ds_read_b128 v[208:211], v252 offset:4096
    ds_read_b128 v[212:215], v252 offset:5120
    s_waitcnt lgkmcnt(3)
    v_mfma_f32_32x32x16_bf16 v[160:175], v[216:219], v[244:247], 0
    v_max3_f32 v228, v112, v113, v114
    v_max3_f32 v229, v128, v129, v130
    v_max3_f32 v228, v228, v115, v116
    v_max3_f32 v229, v229, v131, v132
    v_max3_f32 v228, v228, v117, v118
    v_max3_f32 v229, v229, v133, v134
    v_max3_f32 v228, v228, v119, v120
    v_max3_f32 v229, v229, v135, v136
    s_waitcnt lgkmcnt(2)
    v_mfma_f32_32x32x16_bf16 v[160:175], v[220:223], v[248:251], v[160:175]
    v_max3_f32 v228, v228, v121, v122
    v_max3_f32 v229, v229, v137, v138
    v_max3_f32 v228, v228, v123, v124
    v_max3_f32 v229, v229, v139, v140
    v_max3_f32 v228, v228, v125, v126
    v_max3_f32 v229, v229, v141, v142
    v_max_f32 v228, v228, v127
    v_max_f32 v229, v229, v143
    s_waitcnt lgkmcnt(1)
    v_mfma_f32_32x32x16_bf16 v[176:191], v[208:211], v[244:247], 0
    s_waitcnt lgkmcnt(0)
    v_mfma_f32_32x32x16_bf16 v[176:191], v[212:215], v[248:251], v[176:191]
    ds_read_b128 v[208:211], v252 offset:34816
    ds_read_b128 v[212:215], v252 offset:35840
    v_max3_f32 v230, v144, v145, v146
    v_max3_f32 v231, v160, v161, v162
    v_max3_f32 v230, v230, v147, v148
    v_max3_f32 v231, v231, v163, v164
    v_max3_f32 v230, v230, v149, v150
    v_max3_f32 v231, v231, v165, v166
    v_max3_f32 v230, v230, v151, v152
    v_max3_f32 v231, v231, v167, v168
    v_max3_f32 v230, v230, v153, v154
    v_max3_f32 v231, v231, v169, v170
    v_max3_f32 v230, v230, v155, v156
    v_max3_f32 v231, v231, v171, v172
    v_max3_f32 v230, v230, v157, v158
    v_max3_f32 v231, v231, v173, v174
    v_max_f32 v230, v230, v159
    v_max_f32 v231, v231, v175
    v_max3_f32 v224, v224, v225, v226
    v_max3_f32 v227, v227, v228, v229
    v_max3_f32 v232, v176, v177, v178
    v_max3_f32 v232, v232, v179, v180
    v_max3_f32 v232, v232, v181, v182
    v_max3_f32 v232, v232, v183, v184
    v_max3_f32 v232, v232, v185, v186
    v_max3_f32 v232, v232, v187, v188
    v_max3_f32 v232, v232, v189, v190
    v_max3_f32 v232, v232, v191, v230
    v_max3_f32 v233, v224, v227, v231
    v_max_f32 v233, v233, v232
    v_mov_b32 v234, v233
    s_nop 1
    v_permlane32_swap_b32 v233, v234
    v_max_f32 v233, v233, v234
    v_cvt_pk_bf16_f32 v224, v233, v233
    v_lshlrev_b32 v224, 16, v224
    v_sub_f32 v224, v233, v224
    v_cvt_pk_bf16_f32 v240, v233, v224
    v_and_b32 v225, 0xffff0000, v240
    v_sub_f32 v225, v224, v225
    v_cvt_pk_bf16_f32 v241, v225, v10
    s_nop 1
    v_mfma_f32_32x32x16_bf16 v[64:79], v[236:239], v[240:243], v[64:79]
    v_mfma_f32_32x32x16_bf16 v[80:95], v[236:239], v[240:243], v[80:95]
    v_sub_f32 v48, v48, v233
    v_sub_f32 v49, v49, v233
    v_sub_f32 v50, v50, v233
    v_sub_f32 v51, v51, v233
    v_sub_f32 v52, v52, v233
    v_sub_f32 v53, v53, v233
    v_sub_f32 v54, v54, v233
    v_sub_f32 v55, v55, v233
    v_sub_f32 v56, v56, v233
    v_sub_f32 v57, v57, v233
    v_sub_f32 v58, v58, v233
    v_sub_f32 v59, v59, v233
    v_sub_f32 v60, v60, v233
    v_sub_f32 v61, v61, v233
    v_sub_f32 v62, v62, v233
    v_sub_f32 v63, v63, v233
    ds_read_b128 v[216:219], v252 offset:2048
    ds_read_b128 v[220:223], v252 offset:3072
    v_exp_f32 v48, v48
    v_exp_f32 v49, v49
    v_exp_f32 v50, v50
    v_exp_f32 v51, v51
    v_exp_f32 v52, v52
    v_exp_f32 v53, v53
    v_exp_f32 v54, v54
    v_exp_f32 v55, v55
    v_mfma_f32_32x32x16_bf16 v[96:111], v[236:239], v[240:243], v[96:111]
    v_exp_f32 v56, v56
    v_exp_f32 v57, v57
    v_exp_f32 v58, v58
    v_exp_f32 v59, v59
    v_exp_f32 v60, v60
    v_exp_f32 v61, v61
    v_exp_f32 v62, v62
    v_exp_f32 v63, v63
    v_cvt_pk_bf16_f32 v48, v48, v49
    v_cvt_pk_bf16_f32 v49, v50, v51
    v_cvt_pk_bf16_f32 v50, v52, v53
    v_cvt_pk_bf16_f32 v51, v54, v55
    v_cvt_pk_bf16_f32 v52, v56, v57
    v_cvt_pk_bf16_f32 v53, v58, v59
    v_cvt_pk_bf16_f32 v54, v60, v61
    v_cvt_pk_bf16_f32 v55, v62, v63
    s_waitcnt lgkmcnt(3)
    v_mfma_f32_32x32x16_bf16 v[192:207], v[208:211], v[48:51], 0
    s_waitcnt lgkmcnt(2)
    v_mfma_f32_32x32x16_bf16 v[192:207], v[212:215], v[52:55], v[192:207]
    ds_read_b128 v[208:211], v252 offset:30720
    ds_read_b128 v[212:215], v252 offset:31744
    v_exp_f32 v64, v64
    v_exp_f32 v65, v65
    v_exp_f32 v66, v66
    v_exp_f32 v67, v67
    v_exp_f32 v68, v68
    v_exp_f32 v69, v69
    v_exp_f32 v70, v70
    v_exp_f32 v71, v71
    v_mfma_f32_32x32x16_bf16 v[112:127], v[236:239], v[240:243], v[112:127]
    v_exp_f32 v72, v72
    v_exp_f32 v73, v73
    v_exp_f32 v74, v74
    v_exp_f32 v75, v75
    v_exp_f32 v76, v76
    v_exp_f32 v77, v77
    v_exp_f32 v78, v78
    v_exp_f32 v79, v79
    v_cvt_pk_bf16_f32 v64, v64, v65
    v_cvt_pk_bf16_f32 v65, v66, v67
    v_cvt_pk_bf16_f32 v66, v68, v69
    v_cvt_pk_bf16_f32 v67, v70, v71
    v_cvt_pk_bf16_f32 v68, v72, v73
    v_cvt_pk_bf16_f32 v69, v74, v75
    v_cvt_pk_bf16_f32 v70, v76, v77
    v_cvt_pk_bf16_f32 v71, v78, v79
    s_waitcnt lgkmcnt(3)
    v_mfma_f32_32x32x16_bf16 v[192:207], v[216:219], v[64:67], v[192:207]
    s_waitcnt lgkmcnt(2)
    v_mfma_f32_32x32x16_bf16 v[192:207], v[220:223], v[68:71], v[192:207]
    ds_read_b128 v[216:219], v252 offset:26624
    ds_read_b128 v[220:223], v252 offset:27648
    v_exp_f32 v80, v80
    v_exp_f32 v81, v81
    v_exp_f32 v82, v82
    v_exp_f32 v83, v83
    v_exp_f32 v84, v84
    v_exp_f32 v85, v85
    v_exp_f32 v86, v86
    v_exp_f32 v87, v87
    v_mfma_f32_32x32x16_bf16 v[128:143], v[236:239], v[240:243], v[128:143]
    v_exp_f32 v88, v88
    v_exp_f32 v89, v89
    v_exp_f32 v90, v90
    v_exp_f32 v91, v91
    v_exp_f32 v92, v92
    v_exp_f32 v93, v93
    v_exp_f32 v94, v94
    v_exp_f32 v95, v95
    v_cvt_pk_bf16_f32 v80, v80, v81
    v_cvt_pk_bf16_f32 v81, v82, v83
    v_cvt_pk_bf16_f32 v82, v84, v85
    v_cvt_pk_bf16_f32 v83, v86, v87
    v_cvt_pk_bf16_f32 v84, v88, v89
    v_cvt_pk_bf16_f32 v85, v90, v91
    v_cvt_pk_bf16_f32 v86, v92, v93
    v_cvt_pk_bf16_f32 v87, v94, v95
    s_waitcnt lgkmcnt(3)
    v_mfma_f32_32x32x16_bf16 v[192:207], v[208:211], v[80:83], v[192:207]
    s_waitcnt lgkmcnt(2)
    v_mfma_f32_32x32x16_bf16 v[192:207], v[212:215], v[84:87], v[192:207]
    ds_read_b128 v[208:211], v252 offset:22528
    ds_read_b128 v[212:215], v252 offset:23552
    v_exp_f32 v96, v96
    v_exp_f32 v97, v97
    v_exp_f32 v98, v98
    v_exp_f32 v99, v99
    v_exp_f32 v100, v100
    v_exp_f32 v101, v101
    v_exp_f32 v102, v102
    v_exp_f32 v103, v103
    v_mfma_f32_32x32x16_bf16 v[144:159], v[236:239], v[240:243], v[144:159]
    v_exp_f32 v104, v104
    v_exp_f32 v105, v105
    v_exp_f32 v106, v106
    v_exp_f32 v107, v107
    v_exp_f32 v108, v108
    v_exp_f32 v109, v109
    v_exp_f32 v110, v110
    v_exp_f32 v111, v111
    v_cvt_pk_bf16_f32 v96, v96, v97
    v_cvt_pk_bf16_f32 v97, v98, v99
    v_cvt_pk_bf16_f32 v98, v100, v101
    v_cvt_pk_bf16_f32 v99, v102, v103
    v_cvt_pk_bf16_f32 v100, v104, v105
    v_cvt_pk_bf16_f32 v101, v106, v107
    v_cvt_pk_bf16_f32 v102, v108, v109
    v_cvt_pk_bf16_f32 v103, v110, v111
    s_waitcnt lgkmcnt(3)
    v_mfma_f32_32x32x16_bf16 v[192:207], v[216:219], v[96:99], v[192:207]
    s_waitcnt lgkmcnt(2)
    v_mfma_f32_32x32x16_bf16 v[192:207], v[220:223], v[100:103], v[192:207]
    ds_read_b128 v[216:219], v252 offset:18432
    ds_read_b128 v[220:223], v252 offset:19456
    v_exp_f32 v112, v112
    v_exp_f32 v113, v113
    v_exp_f32 v114, v114
    v_exp_f32 v115, v115
    v_exp_f32 v116, v116
    v_exp_f32 v117, v117
    v_exp_f32 v118, v118
    v_exp_f32 v119, v119
    v_mfma_f32_32x32x16_bf16 v[160:175], v[236:239], v[240:243], v[160:175]
    v_exp_f32 v120, v120
    v_exp_f32 v121, v121
    v_exp_f32 v122, v122
    v_exp_f32 v123, v123
    v_exp_f32 v124, v124
    v_exp_f32 v125, v125
    v_exp_f32 v126, v126
    v_exp_f32 v127, v127
    v_cvt_pk_bf16_f32 v112, v112, v113
    v_cvt_pk_bf16_f32 v113, v114, v115
    v_cvt_pk_bf16_f32 v114, v116, v117
    v_cvt_pk_bf16_f32 v115, v118, v119
    v_cvt_pk_bf16_f32 v116, v120, v121
    v_cvt_pk_bf16_f32 v117, v122, v123
    v_cvt_pk_bf16_f32 v118, v124, v125
    v_cvt_pk_bf16_f32 v119, v126, v127
    s_waitcnt lgkmcnt(3)
    v_mfma_f32_32x32x16_bf16 v[192:207], v[208:211], v[112:115], v[192:207]
    s_waitcnt lgkmcnt(2)
    v_mfma_f32_32x32x16_bf16 v[192:207], v[212:215], v[116:119], v[192:207]
    ds_read_b128 v[208:211], v252 offset:14336
    ds_read_b128 v[212:215], v252 offset:15360
    v_exp_f32 v128, v128
    v_exp_f32 v129, v129
    v_exp_f32 v130, v130
    v_exp_f32 v131, v131
    v_exp_f32 v132, v132
    v_exp_f32 v133, v133
    v_exp_f32 v134, v134
    v_exp_f32 v135, v135
    v_mfma_f32_32x32x16_bf16 v[176:191], v[236:239], v[240:243], v[176:191]
    v_exp_f32 v136, v136
    v_exp_f32 v137, v137
    v_exp_f32 v138, v138
    v_exp_f32 v139, v139
    v_exp_f32 v140, v140
    v_exp_f32 v141, v141
    v_exp_f32 v142, v142
    v_exp_f32 v143, v143
    v_cvt_pk_bf16_f32 v128, v128, v129
    v_cvt_pk_bf16_f32 v129, v130, v131
    v_cvt_pk_bf16_f32 v130, v132, v133
    v_cvt_pk_bf16_f32 v131, v134, v135
    v_cvt_pk_bf16_f32 v132, v136, v137
    v_cvt_pk_bf16_f32 v133, v138, v139
    v_cvt_pk_bf16_f32 v134, v140, v141
    v_cvt_pk_bf16_f32 v135, v142, v143
    s_waitcnt lgkmcnt(3)
    v_mfma_f32_32x32x16_bf16 v[192:207], v[216:219], v[128:131], v[192:207]
    s_waitcnt lgkmcnt(2)
    v_mfma_f32_32x32x16_bf16 v[192:207], v[220:223], v[132:135], v[192:207]
    ds_read_b128 v[216:219], v252 offset:10240
    ds_read_b128 v[220:223], v252 offset:11264
    v_exp_f32 v144, v144
    v_exp_f32 v145, v145
    v_exp_f32 v146, v146
    v_exp_f32 v147, v147
    v_exp_f32 v148, v148
    v_exp_f32 v149, v149
    v_exp_f32 v150, v150
    v_exp_f32 v151, v151
    v_exp_f32 v152, v152
    v_exp_f32 v153, v153
    v_exp_f32 v154, v154
    v_exp_f32 v155, v155
    v_exp_f32 v156, v156
    v_exp_f32 v157, v157
    v_exp_f32 v158, v158
    v_exp_f32 v159, v159
    v_cvt_pk_bf16_f32 v144, v144, v145
    v_cvt_pk_bf16_f32 v145, v146, v147
    v_cvt_pk_bf16_f32 v146, v148, v149
    v_cvt_pk_bf16_f32 v147, v150, v151
    v_cvt_pk_bf16_f32 v148, v152, v153
    v_cvt_pk_bf16_f32 v149, v154, v155
    v_cvt_pk_bf16_f32 v150, v156, v157
    v_cvt_pk_bf16_f32 v151, v158, v159
    s_waitcnt lgkmcnt(3)
    v_mfma_f32_32x32x16_bf16 v[192:207], v[208:211], v[144:147], v[192:207]
    s_waitcnt lgkmcnt(2)
    v_mfma_f32_32x32x16_bf16 v[192:207], v[212:215], v[148:151], v[192:207]
    ds_read_b128 v[208:211], v252 offset:6144
    ds_read_b128 v[212:215], v252 offset:7168
    v_exp_f32 v160, v160
    v_exp_f32 v161, v161
    v_exp_f32 v162, v162
    v_exp_f32 v163, v163
    v_exp_f32 v164, v164
    v_exp_f32 v165, v165
    v_exp_f32 v166, v166
    v_exp_f32 v167, v167
    v_exp_f32 v168, v168
    v_exp_f32 v169, v169
    v_exp_f32 v170, v170
    v_exp_f32 v171, v171
    v_exp_f32 v172, v172
    v_exp_f32 v173, v173
    v_exp_f32 v174, v174
    v_exp_f32 v175, v175
    v_cvt_pk_bf16_f32 v160, v160, v161
    v_cvt_pk_bf16_f32 v161, v162, v163
    v_cvt_pk_bf16_f32 v162, v164, v165
    v_cvt_pk_bf16_f32 v163, v166, v167
    v_cvt_pk_bf16_f32 v164, v168, v169
    v_cvt_pk_bf16_f32 v165, v170, v171
    v_cvt_pk_bf16_f32 v166, v172, v173
    v_cvt_pk_bf16_f32 v167, v174, v175
    s_waitcnt lgkmcnt(3)
    v_mfma_f32_32x32x16_bf16 v[192:207], v[216:219], v[160:163], v[192:207]
    s_waitcnt lgkmcnt(2)
    v_mfma_f32_32x32x16_bf16 v[192:207], v[220:223], v[164:167], v[192:207]
    v_exp_f32 v176, v176
    v_exp_f32 v177, v177
    v_exp_f32 v178, v178
    v_exp_f32 v179, v179
    v_exp_f32 v180, v180
    v_exp_f32 v181, v181
    v_exp_f32 v182, v182
    v_exp_f32 v183, v183
    v_exp_f32 v184, v184
    v_exp_f32 v185, v185
    v_exp_f32 v186, v186
    v_exp_f32 v187, v187
    v_exp_f32 v188, v188
    v_exp_f32 v189, v189
    v_exp_f32 v190, v190
    v_exp_f32 v191, v191
    v_cvt_pk_bf16_f32 v176, v176, v177
    v_cvt_pk_bf16_f32 v177, v178, v179
    v_cvt_pk_bf16_f32 v178, v180, v181
    v_cvt_pk_bf16_f32 v179, v182, v183
    v_cvt_pk_bf16_f32 v180, v184, v185
    v_cvt_pk_bf16_f32 v181, v186, v187
    v_cvt_pk_bf16_f32 v182, v188, v189
    v_cvt_pk_bf16_f32 v183, v190, v191
    s_waitcnt lgkmcnt(1)
    v_mfma_f32_32x32x16_bf16 v[192:207], v[208:211], v[176:179], v[192:207]
    s_waitcnt lgkmcnt(0)
    v_mfma_f32_32x32x16_bf16 v[192:207], v[212:215], v[180:183], v[192:207]
    s_add_u32 s53, s48, 32768
    s_nop 10
    v_mov_b32 v224, v204
    v_mov_b32 v225, v204
    s_nop 1
    v_permlane32_swap_b32 v224, v225
    v_rcp_f32 v225, v225
    s_nop 0
    v_mul_f32 v192, v192, v225
    v_mul_f32 v193, v193, v225
    v_mul_f32 v194, v194, v225
    v_mul_f32 v195, v195, v225
    v_mul_f32 v196, v196, v225
    v_mul_f32 v197, v197, v225
    v_mul_f32 v198, v198, v225
    v_mul_f32 v199, v199, v225
    v_mul_f32 v200, v200, v225
    v_mul_f32 v201, v201, v225
    v_mul_f32 v202, v202, v225
    v_mul_f32 v203, v203, v225
    v_mul_f32 v204, v204, v225
    v_mul_f32 v205, v205, v225
    v_mul_f32 v206, v206, v225
    v_mul_f32 v207, v207, v225
    v_cvt_pk_bf16_f32 v48, v192, v193
    v_cvt_pk_bf16_f32 v49, v194, v195
    v_cvt_pk_bf16_f32 v50, v196, v197
    v_cvt_pk_bf16_f32 v51, v198, v199
    v_cvt_pk_bf16_f32 v52, v200, v201
    v_cvt_pk_bf16_f32 v53, v202, v203
    v_cvt_pk_bf16_f32 v54, v204, v205
    v_cvt_pk_bf16_f32 v55, v206, v207
    s_cmp_eq_u32 s61, 1
    s_cbranch_scc1 L_msl1
    buffer_store_dwordx2 v[48:49], v14, s[8:11], s53 offen sc1
    buffer_store_dwordx2 v[50:51], v15, s[8:11], s53 offen sc1
    buffer_store_dwordx2 v[52:53], v16, s[8:11], s53 offen sc1
    s_mov_b64 exec, 0xffffffff
    buffer_store_dwordx2 v[54:55], v17, s[8:11], s53 offen sc1
    s_mov_b64 exec, -1
    s_branch L_mse1
L_msl1:
    buffer_store_dwordx2 v[48:49], v14, s[8:11], s53 offen
    buffer_store_dwordx2 v[50:51], v15, s[8:11], s53 offen
    buffer_store_dwordx2 v[52:53], v16, s[8:11], s53 offen
    s_mov_b64 exec, 0xffffffff
    buffer_store_dwordx2 v[54:55], v17, s[8:11], s53 offen
    s_mov_b64 exec, -1
L_mse1:
    s_lshl_b32 s54, s45, 2
    s_add_u32 s54, s54, s49
    s_waitcnt vmcnt(0)
    s_waitcnt vmcnt(0)
    s_mov_b64 exec, 1
    s_cmp_eq_u32 s61, 1
    s_cbranch_scc1 L_msl2
    buffer_store_dword v9, v10, s[8:11], s54 offen offset:64 sc1
    s_branch L_mse2
L_msl2:
    buffer_store_dword v9, v10, s[8:11], s54 offen offset:64
L_mse2:
    s_mov_b64 exec, -1
    s_barrier
    s_cmp_ge_u32 s45, 14
    s_cbranch_scc1 L_cnext
    v_mov_b32 v5, v18
    v_add_u32 v3, s63, v5
    v_add_u32 v4, s64, v5
    v_add_u32 v5, 114688, v5
    v_mfma_f32_32x32x16_bf16 v[160:175], v[40:43], v[24:27], 0
    v_mfma_f32_32x32x16_bf16 v[160:175], v[44:47], v[28:31], v[160:175]
    v_mov_b32 v180, -1
    v_mov_b32 v181, -1
    v_mov_b32 v182, -1
    v_mov_b32 v183, -1
    s_waitcnt vmcnt(0)
    s_nop 5
    s_mov_b32 s51, 0
L_poll2:
    buffer_load_dword v176, v7, s[8:11], s49 offen offset:64 sc1
    s_add_u32 s51, s51, 1
    s_cmp_gt_u32 s51, 0x40000
    s_cbranch_scc1 L_end
    s_waitcnt vmcnt(0)
    v_cmp_eq_u32 vcc, 0, v176
    s_nop 1
    s_and_b32 s57, vcc_lo, 0xffff
    s_cbranch_scc1 L_poll2
    s_add_u32 s72, s48, 32768
    buffer_load_dwordx4 v[48:51], v2, s[8:11], s72 offen offset:0 sc1
    buffer_load_dwordx4 v[52:55], v2, s[8:11], s72 offen offset:1024 sc1
    buffer_load_dwordx4 v[56:59], v2, s[8:11], s72 offen offset:2048 sc1
    buffer_load_dwordx4 v[60:63], v2, s[8:11], s72 offen offset:3072 sc1
    buffer_load_dwordx4 v[64:67], v13, s[8:11], s72 offen offset:0 sc1
    buffer_load_dwordx4 v[68:71], v13, s[8:11], s72 offen offset:1024 sc1
    buffer_load_dwordx4 v[72:75], v13, s[8:11], s72 offen offset:2048 sc1
    buffer_load_dwordx4 v[76:79], v13, s[8:11], s72 offen offset:3072 sc1
    s_add_u32 s72, s72, 8192
    buffer_load_dwordx4 v[80:83], v2, s[8:11], s72 offen offset:0 sc1
    buffer_load_dwordx4 v[84:87], v2, s[8:11], s72 offen offset:1024 sc1
    buffer_load_dwordx4 v[88:91], v2, s[8:11], s72 offen offset:2048 sc1
    buffer_load_dwordx4 v[92:95], v2, s[8:11], s72 offen offset:3072 sc1
    buffer_load_dwordx4 v[96:99], v13, s[8:11], s72 offen offset:0 sc1
    buffer_load_dwordx4 v[100:103], v13, s[8:11], s72 offen offset:1024 sc1
    buffer_load_dwordx4 v[104:107], v13, s[8:11], s72 offen offset:2048 sc1
    buffer_load_dwordx4 v[108:111], v13, s[8:11], s72 offen offset:3072 sc1
    ds_read_b64_tr_b16 v[208:209], v5 offset:20480
    ds_read_b64_tr_b16 v[210:211], v5 offset:20992
    ds_read_b64_tr_b16 v[212:213], v5 offset:21504
    ds_read_b64_tr_b16 v[214:215], v5 offset:22016
    ds_read_b64_tr_b16 v[216:217], v5 offset:22528
    ds_read_b64_tr_b16 v[218:219], v5 offset:23040
    ds_read_b64_tr_b16 v[220:221], v5 offset:23552
    ds_read_b64_tr_b16 v[222:223], v5 offset:24064
    s_waitcnt vmcnt(15) lgkmcnt(6)
    v_mfma_f32_32x32x16_bf16 v[160:175], v[208:211], v[48:51], v[160:175]
    s_add_u32 s72, s72, 8192
    buffer_load_dwordx4 v[112:115], v2, s[8:11], s72 offen offset:0 sc1
    ds_read_b64_tr_b16 v[208:209], v5 offset:24576
    ds_read_b64_tr_b16 v[210:211], v5 offset:25088
    s_waitcnt vmcnt(15) lgkmcnt(6)
    v_mfma_f32_32x32x16_bf16 v[160:175], v[212:215], v[52:55], v[160:175]
    buffer_load_dwordx4 v[116:119], v2, s[8:11], s72 offen offset:1024 sc1
    ds_read_b64_tr_b16 v[212:213], v5 offset:25600
    ds_read_b64_tr_b16 v[214:215], v5 offset:26112
    s_waitcnt vmcnt(15) lgkmcnt(6)
    v_mfma_f32_32x32x16_bf16 v[160:175], v[216:219], v[56:59], v[160:175]
    buffer_load_dwordx4 v[120:123], v2, s[8:11], s72 offen offset:2048 sc1
    ds_read_b64_tr_b16 v[216:217], v5 offset:26624
    ds_read_b64_tr_b16 v[218:219], v5 offset:27136
    s_waitcnt vmcnt(15) lgkmcnt(6)
    v_mfma_f32_32x32x16_bf16 v[160:175], v[220:223], v[60:63], v[160:175]
    buffer_load_dwordx4 v[124:127], v2, s[8:11], s72 offen offset:3072 sc1
    ds_read_b64_tr_b16 v[220:221], v5 offset:27648
    ds_read_b64_tr_b16 v[222:223], v5 offset:28160
    s_waitcnt vmcnt(15) lgkmcnt(6)
    v_mfma_f32_32x32x16_bf16 v[160:175], v[208:211], v[64:67], v[160:175]
    buffer_load_dwordx4 v[128:131], v13, s[8:11], s72 offen offset:0 sc1
    ds_read_b64_tr_b16 v[208:209], v5 offset:28672
    ds_read_b64_tr_b16 v[210:211], v5 offset:29184
    s_waitcnt vmcnt(15) lgkmcnt(6)
    v_mfma_f32_32x32x16_bf16 v[160:175], v[212:215], v[68:71], v[160:175]
    buffer_load_dwordx4 v[132:135], v13, s[8:11], s72 offen offset:1024 sc1
    ds_read_b64_tr_b16 v[212:213], v5 offset:29696
    ds_read_b64_tr_b16 v[214:215], v5 offset:30208
    s_waitcnt vmcnt(15) lgkmcnt(6)
    v_mfma_f32_32x32x16_bf16 v[160:175], v[216:219], v[72:75], v[160:175]
    buffer_load_dwordx4 v[136:139], v13, s[8:11], s72 offen offset:2048 sc1
    ds_read_b64_tr_b16 v[216:217], v5 offset:30720
    ds_read_b64_tr_b16 v[218:219], v5 offset:31232
    s_waitcnt vmcnt(15) lgkmcnt(6)
    v_mfma_f32_32x32x16_bf16 v[160:175], v[220:223], v[76:79], v[160:175]
    buffer_load_dwordx4 v[140:143], v13, s[8:11], s72 offen offset:3072 sc1
    ds_read_b64_tr_b16 v[220:221], v5 offset:31744
    ds_read_b64_tr_b16 v[222:223], v5 offset:32256
    s_waitcnt vmcnt(15) lgkmcnt(6)
    v_mfma_f32_32x32x16_bf16 v[160:175], v[208:211], v[80:83], v[160:175]
    s_add_u32 s72, s72, 8192
    buffer_load_dwordx4 v[144:147], v2, s[8:11], s72 offen offset:0 sc1
    ds_read_b64_tr_b16 v[208:209], v5 offset:32768
    ds_read_b64_tr_b16 v[210:211], v5 offset:33280
    s_waitcnt vmcnt(15) lgkmcnt(6)
    v_mfma_f32_32x32x16_bf16 v[160:175], v[212:215], v[84:87], v[160:175]
    buffer_load_dwordx4 v[148:151], v2, s[8:11], s72 offen offset:1024 sc1
    ds_read_b64_tr_b16 v[212:213], v5 offset:33792
    ds_read_b64_tr_b16 v[214:215], v5 offset:34304
    s_waitcnt vmcnt(15) lgkmcnt(6)
    v_mfma_f32_32x32x16_bf16 v[160:175], v[216:219], v[88:91], v[160:175]
    buffer_load_dwordx4 v[152:155], v2, s[8:11], s72 offen offset:2048 sc1
    ds_read_b64_tr_b16 v[216:217], v5 offset:34816
    ds_read_b64_tr_b16 v[218:219], v5 offset:35328
    s_waitcnt vmcnt(15) lgkmcnt(6)
    v_mfma_f32_32x32x16_bf16 v[160:175], v[220:223], v[92:95], v[160:175]
    buffer_load_dwordx4 v[156:159], v2, s[8:11], s72 offen offset:3072 sc1
    ds_read_b64_tr_b16 v[220:221], v5 offset:35840
    ds_read_b64_tr_b16 v[222:223], v5 offset:36352
    s_waitcnt vmcnt(15) lgkmcnt(6)
    v_mfma_f32_32x32x16_bf16 v[160:175], v[208:211], v[96:99], v[160:175]
    ds_read_b64_tr_b16 v[208:209], v5 offset:36864
    ds_read_b64_tr_b16 v[210:211], v5 offset:37376
    s_waitcnt vmcnt(14) lgkmcnt(6)
    v_mfma_f32_32x32x16_bf16 v[160:175], v[212:215], v[100:103], v[160:175]
    ds_read_b64_tr_b16 v[212:213], v5 offset:37888
    ds_read_b64_tr_b16 v[214:215], v5 offset:38400
    s_waitcnt vmcnt(13) lgkmcnt(6)
    v_mfma_f32_32x32x16_bf16 v[160:175], v[216:219], v[104:107], v[160:175]
    ds_read_b64_tr_b16 v[216:217], v5 offset:38912
    ds_read_b64_tr_b16 v[218:219], v5 offset:39424
    s_waitcnt vmcnt(12) lgkmcnt(6)
    v_mfma_f32_32x32x16_bf16 v[160:175], v[220:223], v[108:111], v[160:175]
    ds_read_b64_tr_b16 v[220:221], v5 offset:39936
    ds_read_b64_tr_b16 v[222:223], v5 offset:40448
    s_waitcnt vmcnt(11) lgkmcnt(6)
    v_mfma_f32_32x32x16_bf16 v[160:175], v[208:211], v[112:115], v[160:175]
    ds_read_b64_tr_b16 v[208:209], v5 offset:40960
    ds_read_b64_tr_b16 v[210:211], v5 offset:41472
    s_waitcnt vmcnt(10) lgkmcnt(6)
    v_mfma_f32_32x32x16_bf16 v[160:175], v[212:215], v[116:119], v[160:175]
    ds_read_b64_tr_b16 v[212:213], v5 offset:41984
    ds_read_b64_tr_b16 v[214:215], v5 offset:42496
    s_waitcnt vmcnt(9) lgkmcnt(6)
    v_mfma_f32_32x32x16_bf16 v[160:175], v[216:219], v[120:123], v[160:175]
    ds_read_b64_tr_b16 v[216:217], v5 offset:43008
    ds_read_b64_tr_b16 v[218:219], v5 offset:43520
    s_waitcnt vmcnt(8) lgkmcnt(6)
    v_mfma_f32_32x32x16_bf16 v[160:175], v[220:223], v[124:127], v[160:175]
    ds_read_b64_tr_b16 v[220:221], v5 offset:44032
    ds_read_b64_tr_b16 v[222:223], v5 offset:44544
    s_waitcnt vmcnt(7) lgkmcnt(6)
    v_mfma_f32_32x32x16_bf16 v[160:175], v[208:211], v[128:131], v[160:175]
    ds_read_b64_tr_b16 v[208:209], v5 offset:45056
    ds_read_b64_tr_b16 v[210:211], v5 offset:45568
    s_waitcnt vmcnt(6) lgkmcnt(6)
    v_mfma_f32_32x32x16_bf16 v[160:175], v[212:215], v[132:135], v[160:175]
    ds_read_b64_tr_b16 v[212:213], v5 offset:46080
    ds_read_b64_tr_b16 v[214:215], v5 offset:46592
    s_waitcnt vmcnt(5) lgkmcnt(6)
    v_mfma_f32_32x32x16_bf16 v[160:175], v[216:219], v[136:139], v[160:175]
    ds_read_b64_tr_b16 v[216:217], v5 offset:47104
    ds_read_b64_tr_b16 v[218:219], v5 offset:47616
    s_waitcnt vmcnt(4) lgkmcnt(6)
    v_mfma_f32_32x32x16_bf16 v[160:175], v[220:223], v[140:143], v[160:175]
    ds_read_b64_tr_b16 v[220:221], v5 offset:48128
    ds_read_b64_tr_b16 v[222:223], v5 offset:48640
    s_waitcnt vmcnt(3) lgkmcnt(6)
    v_mfma_f32_32x32x16_bf16 v[160:175], v[208:211], v[144:147], v[160:175]
    s_waitcnt vmcnt(2) lgkmcnt(4)
    v_mfma_f32_32x32x16_bf16 v[160:175], v[212:215], v[148:151], v[160:175]
    s_waitcnt vmcnt(1) lgkmcnt(2)
    v_mfma_f32_32x32x16_bf16 v[160:175], v[216:219], v[152:155], v[160:175]
    s_waitcnt vmcnt(0) lgkmcnt(0)
    v_mfma_f32_32x32x16_bf16 v[160:175], v[220:223], v[156:159], v[160:175]
    s_cmp_eq_u32 s61, 1
    s_cbranch_scc1 L_msl3
    buffer_store_dwordx4 v[180:183], v2, s[8:11], s73 offen sc1
    buffer_store_dwordx4 v[180:183], v2, s[8:11], s73 offen offset:1024 sc1
    s_branch L_mse3
L_msl3:
    buffer_store_dwordx4 v[180:183], v2, s[8:11], s73 offen
    buffer_store_dwordx4 v[180:183], v2, s[8:11], s73 offen offset:1024
L_mse3:
    s_nop 7
    v_cvt_pk_bf16_f32 v24, v160, v161
    v_cvt_pk_bf16_f32 v25, v162, v163
    v_cvt_pk_bf16_f32 v26, v164, v165
    v_cvt_pk_bf16_f32 v27, v166, v167
    v_cvt_pk_bf16_f32 v28, v168, v169
    v_cvt_pk_bf16_f32 v29, v170, v171
    v_cvt_pk_bf16_f32 v30, v172, v173
    v_cvt_pk_bf16_f32 v31, v174, v175
    s_add_u32 s53, s73, 61440
    s_cmp_eq_u32 s61, 1
    s_cbranch_scc1 L_msl4
    buffer_store_dwordx4 v[24:27], v2, s[8:11], s53 offen sc1
    buffer_store_dwordx4 v[28:31], v2, s[8:11], s53 offen offset:1024 sc1
    s_branch L_mse4
L_msl4:
    buffer_store_dwordx4 v[24:27], v2, s[8:11], s53 offen
    buffer_store_dwordx4 v[28:31], v2, s[8:11], s53 offen offset:1024
L_mse4:
    v_mov_b32 v176, 0
    v_mov_b32 v177, 0
    v_mov_b32 v178, 0
    v_mov_b32 v179, 0
    v_mov_b32 v180, 0x3f803f80
    v_dot2_f32_bf16 v176, v24, v180, v176
    v_dot2_f32_bf16 v177, v24, v24, v177
    v_dot2_f32_bf16 v178, v25, v180, v178
    v_dot2_f32_bf16 v179, v25, v25, v179
    v_dot2_f32_bf16 v176, v26, v180, v176
    v_dot2_f32_bf16 v177, v26, v26, v177
    v_dot2_f32_bf16 v178, v27, v180, v178
    v_dot2_f32_bf16 v179, v27, v27, v179
    v_dot2_f32_bf16 v176, v28, v180, v176
    v_dot2_f32_bf16 v177, v28, v28, v177
    v_dot2_f32_bf16 v178, v29, v180, v178
    v_dot2_f32_bf16 v179, v29, v29, v179
    v_dot2_f32_bf16 v176, v30, v180, v176
    v_dot2_f32_bf16 v177, v30, v30, v177
    v_dot2_f32_bf16 v178, v31, v180, v178
    v_dot2_f32_bf16 v179, v31, v31, v179
    s_lshl_b32 s54, s62, 8
    s_add_u32 s53, s48, s54
    s_add_u32 s53, s53, 90112
    v_lshlrev_b32 v181, 3, v1
    v_add_f32 v176, v176, v178
    v_add_f32 v177, v177, v179
    v_mov_b32 v179, v176
    s_nop 1
    v_permlane32_swap_b32 v176, v179
    v_add_f32 v176, v176, v179
    v_mov_b32 v180, v177
    s_nop 1
    v_permlane32_swap_b32 v177, v180
    v_add_f32 v177, v177, v180
    s_mov_b32 s58, -1
    s_mov_b32 s59, 0
    s_mov_b64 exec, s[58:59]
    s_cmp_eq_u32 s61, 1
    s_cbranch_scc1 L_msl5
    buffer_store_dwordx2 v[176:177], v181, s[8:11], s53 offen sc1
    s_branch L_mse5
L_msl5:
    buffer_store_dwordx2 v[176:177], v181, s[8:11], s53 offen
L_mse5:
    s_mov_b64 exec, -1
    s_lshl_b32 s54, s62, 2
    s_add_u32 s54, s54, s49
    s_add_u32 s54, s54, 128
    s_waitcnt vmcnt(0)
    s_mov_b64 exec, 1
    s_cmp_eq_u32 s61, 1
    s_cbranch_scc1 L_msl6
    buffer_store_dword v9, v10, s[8:11], s54 offen offset:0 sc1
    s_branch L_mse6
L_msl6:
    buffer_store_dword v9, v10, s[8:11], s54 offen offset:0
L_mse6:
    s_mov_b64 exec, -1
    s_barrier
    s_waitcnt vmcnt(0)
    s_mov_b32 s51, 0
L_poll3:
    buffer_load_dword v160, v7, s[8:11], s49 offen offset:128 sc1
    s_add_u32 s51, s51, 1
    s_cmp_gt_u32 s51, 0x40000
    s_cbranch_scc1 L_end
    s_waitcnt vmcnt(0)
    v_cmp_eq_u32 vcc, 0, v160
    s_nop 1
    s_and_b32 s57, vcc_lo, 0x3fff
    s_cbranch_scc1 L_poll3
    s_add_u32 s72, s48, 61440
    buffer_load_dwordx4 v[48:51], v2, s[8:11], s72 offen offset:0 sc1
    buffer_load_dwordx4 v[52:55], v2, s[8:11], s72 offen offset:1024 sc1
    buffer_load_dwordx4 v[56:59], v2, s[8:11], s72 offen offset:2048 sc1
    buffer_load_dwordx4 v[60:63], v2, s[8:11], s72 offen offset:3072 sc1
    buffer_load_dwordx4 v[64:67], v13, s[8:11], s72 offen offset:0 sc1
    buffer_load_dwordx4 v[68:71], v13, s[8:11], s72 offen offset:1024 sc1
    ds_read_b64_tr_b16 v[208:209], v4 offset:28672
    ds_read_b64_tr_b16 v[210:211], v4 offset:29184
    ds_read_b64_tr_b16 v[212:213], v4 offset:0
    ds_read_b64_tr_b16 v[214:215], v4 offset:512
    ds_read_b64_tr_b16 v[216:217], v3 offset:0
    ds_read_b64_tr_b16 v[218:219], v3 offset:512
    ds_read_b64_tr_b16 v[220:221], v3 offset:28672
    ds_read_b64_tr_b16 v[222:223], v3 offset:29184
    s_waitcnt vmcnt(5) lgkmcnt(6)
    v_mfma_f32_32x32x16_bf16 v[160:175], v[208:211], v[48:51], 0
    buffer_load_dwordx4 v[72:75], v13, s[8:11], s72 offen offset:2048 sc1
    ds_read_b64_tr_b16 v[208:209], v4 offset:29696
    ds_read_b64_tr_b16 v[210:211], v4 offset:30208
    s_waitcnt lgkmcnt(6)
    v_mfma_f32_32x32x16_bf16 v[176:191], v[212:215], v[48:51], 0
    ds_read_b64_tr_b16 v[212:213], v4 offset:1024
    ds_read_b64_tr_b16 v[214:215], v4 offset:1536
    s_waitcnt lgkmcnt(6)
    v_mfma_f32_32x32x16_bf16 v[192:207], v[216:219], v[48:51], 0
    buffer_load_dwordx4 v[76:79], v13, s[8:11], s72 offen offset:3072 sc1
    ds_read_b64_tr_b16 v[216:217], v3 offset:1024
    ds_read_b64_tr_b16 v[218:219], v3 offset:1536
    s_waitcnt lgkmcnt(6)
    v_mfma_f32_32x32x16_bf16 v[224:239], v[220:223], v[48:51], 0
    ds_read_b64_tr_b16 v[220:221], v3 offset:29696
    ds_read_b64_tr_b16 v[222:223], v3 offset:30208
    s_waitcnt vmcnt(6) lgkmcnt(6)
    v_mfma_f32_32x32x16_bf16 v[160:175], v[208:211], v[52:55], v[160:175]
    s_add_u32 s72, s72, 8192
    buffer_load_dwordx4 v[80:83], v2, s[8:11], s72 offen offset:0 sc1
    ds_read_b64_tr_b16 v[208:209], v4 offset:30720
    ds_read_b64_tr_b16 v[210:211], v4 offset:31232
    s_waitcnt lgkmcnt(6)
    v_mfma_f32_32x32x16_bf16 v[176:191], v[212:215], v[52:55], v[176:191]
    ds_read_b64_tr_b16 v[212:213], v4 offset:2048
    ds_read_b64_tr_b16 v[214:215], v4 offset:2560
    s_waitcnt lgkmcnt(6)
    v_mfma_f32_32x32x16_bf16 v[192:207], v[216:219], v[52:55], v[192:207]
    buffer_load_dwordx4 v[84:87], v2, s[8:11], s72 offen offset:1024 sc1
    ds_read_b64_tr_b16 v[216:217], v3 offset:2048
    ds_read_b64_tr_b16 v[218:219], v3 offset:2560
    s_waitcnt lgkmcnt(6)
    v_mfma_f32_32x32x16_bf16 v[224:239], v[220:223], v[52:55], v[224:239]
    ds_read_b64_tr_b16 v[220:221], v3 offset:30720
    ds_read_b64_tr_b16 v[222:223], v3 offset:31232
    s_waitcnt vmcnt(7) lgkmcnt(6)
    v_mfma_f32_32x32x16_bf16 v[160:175], v[208:211], v[56:59], v[160:175]
    buffer_load_dwordx4 v[88:91], v2, s[8:11], s72 offen offset:2048 sc1
    ds_read_b64_tr_b16 v[208:209], v4 offset:31744
    ds_read_b64_tr_b16 v[210:211], v4 offset:32256
    s_waitcnt lgkmcnt(6)
    v_mfma_f32_32x32x16_bf16 v[176:191], v[212:215], v[56:59], v[176:191]
    ds_read_b64_tr_b16 v[212:213], v4 offset:3072
    ds_read_b64_tr_b16 v[214:215], v4 offset:3584
    s_waitcnt lgkmcnt(6)
    v_mfma_f32_32x32x16_bf16 v[192:207], v[216:219], v[56:59], v[192:207]
    buffer_load_dwordx4 v[92:95], v2, s[8:11], s72 offen offset:3072 sc1
    ds_read_b64_tr_b16 v[216:217], v3 offset:3072
    ds_read_b64_tr_b16 v[218:219], v3 offset:3584
    s_waitcnt lgkmcnt(6)
    v_mfma_f32_32x32x16_bf16 v[224:239], v[220:223], v[56:59], v[224:239]
    ds_read_b64_tr_b16 v[220:221], v3 offset:31744
    ds_read_b64_tr_b16 v[222:223], v3 offset:32256
    s_waitcnt vmcnt(8) lgkmcnt(6)
    v_mfma_f32_32x32x16_bf16 v[160:175], v[208:211], v[60:63], v[160:175]
    buffer_load_dwordx4 v[96:99], v13, s[8:11], s72 offen offset:0 sc1
    ds_read_b64_tr_b16 v[208:209], v4 offset:32768
    ds_read_b64_tr_b16 v[210:211], v4 offset:33280
    s_waitcnt lgkmcnt(6)
    v_mfma_f32_32x32x16_bf16 v[176:191], v[212:215], v[60:63], v[176:191]
    ds_read_b64_tr_b16 v[212:213], v4 offset:4096
    ds_read_b64_tr_b16 v[214:215], v4 offset:4608
    s_waitcnt lgkmcnt(6)
    v_mfma_f32_32x32x16_bf16 v[192:207], v[216:219], v[60:63], v[192:207]
    buffer_load_dwordx4 v[100:103], v13, s[8:11], s72 offen offset:1024 sc1
    ds_read_b64_tr_b16 v[216:217], v3 offset:4096
    ds_read_b64_tr_b16 v[218:219], v3 offset:4608
    s_waitcnt lgkmcnt(6)
    v_mfma_f32_32x32x16_bf16 v[224:239], v[220:223], v[60:63], v[224:239]
    s_add_u32 s53, s48, 90112
    buffer_load_dwordx2 v[240:241], v6, s[8:11], s53 offen offset:0 sc1
    buffer_load_dwordx2 v[242:243], v6, s[8:11], s53 offen offset:256 sc1
    buffer_load_dwordx2 v[244:245], v6, s[8:11], s53 offen offset:512 sc1
    buffer_load_dwordx2 v[246:247], v6, s[8:11], s53 offen offset:768 sc1
    buffer_load_dwordx2 v[248:249], v6, s[8:11], s53 offen offset:1024 sc1
    buffer_load_dwordx2 v[250:251], v6, s[8:11], s53 offen offset:1280 sc1
    buffer_load_dwordx2 v[252:253], v6, s[8:11], s53 offen offset:1536 sc1
    ds_read_b64_tr_b16 v[220:221], v3 offset:32768
    ds_read_b64_tr_b16 v[222:223], v3 offset:33280
    s_waitcnt vmcnt(16) lgkmcnt(6)
    v_mfma_f32_32x32x16_bf16 v[160:175], v[208:211], v[64:67], v[160:175]
    buffer_load_dwordx4 v[104:107], v13, s[8:11], s72 offen offset:2048 sc1
    ds_read_b64_tr_b16 v[208:209], v4 offset:33792
    ds_read_b64_tr_b16 v[210:211], v4 offset:34304
    s_waitcnt lgkmcnt(6)
    v_mfma_f32_32x32x16_bf16 v[176:191], v[212:215], v[64:67], v[176:191]
    ds_read_b64_tr_b16 v[212:213], v4 offset:5120
    ds_read_b64_tr_b16 v[214:215], v4 offset:5632
    s_waitcnt lgkmcnt(6)
    v_mfma_f32_32x32x16_bf16 v[192:207], v[216:219], v[64:67], v[192:207]
    buffer_load_dwordx4 v[108:111], v13, s[8:11], s72 offen offset:3072 sc1
    ds_read_b64_tr_b16 v[216:217], v3 offset:5120
    ds_read_b64_tr_b16 v[218:219], v3 offset:5632
    s_waitcnt lgkmcnt(6)
    v_mfma_f32_32x32x16_bf16 v[224:239], v[220:223], v[64:67], v[224:239]
    ds_read_b64_tr_b16 v[220:221], v3 offset:33792
    ds_read_b64_tr_b16 v[222:223], v3 offset:34304
    s_waitcnt vmcnt(17) lgkmcnt(6)
    v_mfma_f32_32x32x16_bf16 v[160:175], v[208:211], v[68:71], v[160:175]
    s_add_u32 s72, s72, 8192
    buffer_load_dwordx4 v[112:115], v2, s[8:11], s72 offen offset:0 sc1
    ds_read_b64_tr_b16 v[208:209], v4 offset:34816
    ds_read_b64_tr_b16 v[210:211], v4 offset:35328
    s_waitcnt lgkmcnt(6)
    v_mfma_f32_32x32x16_bf16 v[176:191], v[212:215], v[68:71], v[176:191]
    ds_read_b64_tr_b16 v[212:213], v4 offset:6144
    ds_read_b64_tr_b16 v[214:215], v4 offset:6656
    s_waitcnt lgkmcnt(6)
    v_mfma_f32_32x32x16_bf16 v[192:207], v[216:219], v[68:71], v[192:207]
    buffer_load_dwordx4 v[116:119], v2, s[8:11], s72 offen offset:1024 sc1
    ds_read_b64_tr_b16 v[216:217], v3 offset:6144
    ds_read_b64_tr_b16 v[218:219], v3 offset:6656
    s_waitcnt lgkmcnt(6)
    v_mfma_f32_32x32x16_bf16 v[224:239], v[220:223], v[68:71], v[224:239]
    ds_read_b64_tr_b16 v[220:221], v3 offset:34816
    ds_read_b64_tr_b16 v[222:223], v3 offset:35328
    s_waitcnt vmcnt(18) lgkmcnt(6)
    v_mfma_f32_32x32x16_bf16 v[160:175], v[208:211], v[72:75], v[160:175]
    buffer_load_dwordx4 v[120:123], v2, s[8:11], s72 offen offset:2048 sc1
    ds_read_b64_tr_b16 v[208:209], v4 offset:35840
    ds_read_b64_tr_b16 v[210:211], v4 offset:36352
    s_waitcnt lgkmcnt(6)
    v_mfma_f32_32x32x16_bf16 v[176:191], v[212:215], v[72:75], v[176:191]
    ds_read_b64_tr_b16 v[212:213], v4 offset:7168
    ds_read_b64_tr_b16 v[214:215], v4 offset:7680
    s_waitcnt lgkmcnt(6)
    v_mfma_f32_32x32x16_bf16 v[192:207], v[216:219], v[72:75], v[192:207]
    buffer_load_dwordx4 v[124:127], v2, s[8:11], s72 offen offset:3072 sc1
    ds_read_b64_tr_b16 v[216:217], v3 offset:7168
    ds_read_b64_tr_b16 v[218:219], v3 offset:7680
    s_waitcnt lgkmcnt(6)
    v_mfma_f32_32x32x16_bf16 v[224:239], v[220:223], v[72:75], v[224:239]
    ds_read_b64_tr_b16 v[220:221], v3 offset:35840
    ds_read_b64_tr_b16 v[222:223], v3 offset:36352
    s_waitcnt vmcnt(19) lgkmcnt(6)
    v_mfma_f32_32x32x16_bf16 v[160:175], v[208:211], v[76:79], v[160:175]
    buffer_load_dwordx4 v[128:131], v13, s[8:11], s72 offen offset:0 sc1
    ds_read_b64_tr_b16 v[208:209], v4 offset:36864
    ds_read_b64_tr_b16 v[210:211], v4 offset:37376
    s_waitcnt lgkmcnt(6)
    v_mfma_f32_32x32x16_bf16 v[176:191], v[212:215], v[76:79], v[176:191]
    ds_read_b64_tr_b16 v[212:213], v4 offset:8192
    ds_read_b64_tr_b16 v[214:215], v4 offset:8704
    s_waitcnt lgkmcnt(6)
    v_mfma_f32_32x32x16_bf16 v[192:207], v[216:219], v[76:79], v[192:207]
    buffer_load_dwordx4 v[132:135], v13, s[8:11], s72 offen offset:1024 sc1
    ds_read_b64_tr_b16 v[216:217], v3 offset:8192
    ds_read_b64_tr_b16 v[218:219], v3 offset:8704
    s_waitcnt lgkmcnt(6)
    v_mfma_f32_32x32x16_bf16 v[224:239], v[220:223], v[76:79], v[224:239]
    ds_read_b64_tr_b16 v[220:221], v3 offset:36864
    ds_read_b64_tr_b16 v[222:223], v3 offset:37376
    s_waitcnt vmcnt(20) lgkmcnt(6)
    v_mfma_f32_32x32x16_bf16 v[160:175], v[208:211], v[80:83], v[160:175]
    buffer_load_dwordx4 v[136:139], v13, s[8:11], s72 offen offset:2048 sc1
    ds_read_b64_tr_b16 v[208:209], v4 offset:37888
    ds_read_b64_tr_b16 v[210:211], v4 offset:38400
    s_waitcnt lgkmcnt(6)
    v_mfma_f32_32x32x16_bf16 v[176:191], v[212:215], v[80:83], v[176:191]
    ds_read_b64_tr_b16 v[212:213], v4 offset:9216
    ds_read_b64_tr_b16 v[214:215], v4 offset:9728
    s_waitcnt lgkmcnt(6)
    v_mfma_f32_32x32x16_bf16 v[192:207], v[216:219], v[80:83], v[192:207]
    buffer_load_dwordx4 v[140:143], v13, s[8:11], s72 offen offset:3072 sc1
    ds_read_b64_tr_b16 v[216:217], v3 offset:9216
    ds_read_b64_tr_b16 v[218:219], v3 offset:9728
    s_waitcnt lgkmcnt(6)
    v_mfma_f32_32x32x16_bf16 v[224:239], v[220:223], v[80:83], v[224:239]
    ds_read_b64_tr_b16 v[220:221], v3 offset:37888
    ds_read_b64_tr_b16 v[222:223], v3 offset:38400
    s_waitcnt vmcnt(21) lgkmcnt(6)
    v_mfma_f32_32x32x16_bf16 v[160:175], v[208:211], v[84:87], v[160:175]
    s_add_u32 s72, s72, 8192
    buffer_load_dwordx4 v[144:147], v2, s[8:11], s72 offen offset:0 sc1
    ds_read_b64_tr_b16 v[208:209], v4 offset:38912
    ds_read_b64_tr_b16 v[210:211], v4 offset:39424
    s_waitcnt lgkmcnt(6)
    v_mfma_f32_32x32x16_bf16 v[176:191], v[212:215], v[84:87], v[176:191]
    ds_read_b64_tr_b16 v[212:213], v4 offset:10240
    ds_read_b64_tr_b16 v[214:215], v4 offset:10752
    s_waitcnt lgkmcnt(6)
    v_mfma_f32_32x32x16_bf16 v[192:207], v[216:219], v[84:87], v[192:207]
    buffer_load_dwordx4 v[148:151], v2, s[8:11], s72 offen offset:1024 sc1
    ds_read_b64_tr_b16 v[216:217], v3 offset:10240
    ds_read_b64_tr_b16 v[218:219], v3 offset:10752
    s_waitcnt lgkmcnt(6)
    v_mfma_f32_32x32x16_bf16 v[224:239], v[220:223], v[84:87], v[224:239]
    ds_read_b64_tr_b16 v[220:221], v3 offset:38912
    ds_read_b64_tr_b16 v[222:223], v3 offset:39424
    s_waitcnt vmcnt(22) lgkmcnt(6)
    v_mfma_f32_32x32x16_bf16 v[160:175], v[208:211], v[88:91], v[160:175]
    buffer_load_dwordx4 v[152:155], v2, s[8:11], s72 offen offset:2048 sc1
    ds_read_b64_tr_b16 v[208:209], v4 offset:39936
    ds_read_b64_tr_b16 v[210:211], v4 offset:40448
    s_waitcnt lgkmcnt(6)
    v_mfma_f32_32x32x16_bf16 v[176:191], v[212:215], v[88:91], v[176:191]
    ds_read_b64_tr_b16 v[212:213], v4 offset:11264
    ds_read_b64_tr_b16 v[214:215], v4 offset:11776
    s_waitcnt lgkmcnt(6)
    v_mfma_f32_32x32x16_bf16 v[192:207], v[216:219], v[88:91], v[192:207]
    buffer_load_dwordx4 v[156:159], v2, s[8:11], s72 offen offset:3072 sc1
    ds_read_b64_tr_b16 v[216:217], v3 offset:11264
    ds_read_b64_tr_b16 v[218:219], v3 offset:11776
    s_waitcnt lgkmcnt(6)
    v_mfma_f32_32x32x16_bf16 v[224:239], v[220:223], v[88:91], v[224:239]
    ds_read_b64_tr_b16 v[220:221], v3 offset:39936
    ds_read_b64_tr_b16 v[222:223], v3 offset:40448
    s_waitcnt vmcnt(23) lgkmcnt(6)
    v_mfma_f32_32x32x16_bf16 v[160:175], v[208:211], v[92:95], v[160:175]
    ds_read_b64_tr_b16 v[208:209], v4 offset:40960
    ds_read_b64_tr_b16 v[210:211], v4 offset:41472
    s_waitcnt lgkmcnt(6)
    v_mfma_f32_32x32x16_bf16 v[176:191], v[212:215], v[92:95], v[176:191]
    ds_read_b64_tr_b16 v[212:213], v4 offset:12288
    ds_read_b64_tr_b16 v[214:215], v4 offset:12800
    s_waitcnt lgkmcnt(6)
    v_mfma_f32_32x32x16_bf16 v[192:207], v[216:219], v[92:95], v[192:207]
    ds_read_b64_tr_b16 v[216:217], v3 offset:12288
    ds_read_b64_tr_b16 v[218:219], v3 offset:12800
    s_waitcnt lgkmcnt(6)
    v_mfma_f32_32x32x16_bf16 v[224:239], v[220:223], v[92:95], v[224:239]
    s_cmp_eq_u32 s50, 1
    s_cbranch_scc1 L_b0_15
    s_barrier
L_b0_15:
    ds_read_b64_tr_b16 v[220:221], v3 offset:40960
    ds_read_b64_tr_b16 v[222:223], v3 offset:41472
    s_waitcnt vmcnt(22) lgkmcnt(6)
    v_mfma_f32_32x32x16_bf16 v[160:175], v[208:211], v[96:99], v[160:175]
    ds_read_b64_tr_b16 v[208:209], v4 offset:41984
    ds_read_b64_tr_b16 v[210:211], v4 offset:42496
    s_waitcnt lgkmcnt(6)
    v_mfma_f32_32x32x16_bf16 v[176:191], v[212:215], v[96:99], v[176:191]
    ds_read_b64_tr_b16 v[212:213], v4 offset:13312
    ds_read_b64_tr_b16 v[214:215], v4 offset:13824
    s_waitcnt lgkmcnt(6)
    v_mfma_f32_32x32x16_bf16 v[192:207], v[216:219], v[96:99], v[192:207]
    ds_read_b64_tr_b16 v[216:217], v3 offset:13312
    ds_read_b64_tr_b16 v[218:219], v3 offset:13824
    s_waitcnt lgkmcnt(6)
    v_mfma_f32_32x32x16_bf16 v[224:239], v[220:223], v[96:99], v[224:239]
    ds_read_b64_tr_b16 v[220:221], v3 offset:41984
    ds_read_b64_tr_b16 v[222:223], v3 offset:42496
    s_waitcnt vmcnt(21) lgkmcnt(6)
    v_mfma_f32_32x32x16_bf16 v[160:175], v[208:211], v[100:103], v[160:175]
    ds_read_b64_tr_b16 v[208:209], v4 offset:43008
    ds_read_b64_tr_b16 v[210:211], v4 offset:43520
    s_waitcnt lgkmcnt(6)
    v_mfma_f32_32x32x16_bf16 v[176:191], v[212:215], v[100:103], v[176:191]
    ds_read_b64_tr_b16 v[212:213], v4 offset:14336
    ds_read_b64_tr_b16 v[214:215], v4 offset:14848
    s_waitcnt lgkmcnt(6)
    v_mfma_f32_32x32x16_bf16 v[192:207], v[216:219], v[100:103], v[192:207]
    ds_read_b64_tr_b16 v[216:217], v3 offset:14336
    ds_read_b64_tr_b16 v[218:219], v3 offset:14848
    s_waitcnt lgkmcnt(6)
    v_mfma_f32_32x32x16_bf16 v[224:239], v[220:223], v[100:103], v[224:239]
    ds_read_b64_tr_b16 v[220:221], v3 offset:43008
    ds_read_b64_tr_b16 v[222:223], v3 offset:43520
    s_waitcnt vmcnt(13) lgkmcnt(6)
    v_mfma_f32_32x32x16_bf16 v[160:175], v[208:211], v[104:107], v[160:175]
    ds_read_b64_tr_b16 v[208:209], v4 offset:44032
    ds_read_b64_tr_b16 v[210:211], v4 offset:44544
    s_waitcnt lgkmcnt(6)
    v_mfma_f32_32x32x16_bf16 v[176:191], v[212:215], v[104:107], v[176:191]
    ds_read_b64_tr_b16 v[212:213], v4 offset:15360
    ds_read_b64_tr_b16 v[214:215], v4 offset:15872
    s_waitcnt lgkmcnt(6)
    v_mfma_f32_32x32x16_bf16 v[192:207], v[216:219], v[104:107], v[192:207]
    ds_read_b64_tr_b16 v[216:217], v3 offset:15360
    ds_read_b64_tr_b16 v[218:219], v3 offset:15872
    s_waitcnt lgkmcnt(6)
    v_mfma_f32_32x32x16_bf16 v[224:239], v[220:223], v[104:107], v[224:239]
    ds_read_b64_tr_b16 v[220:221], v3 offset:44032
    ds_read_b64_tr_b16 v[222:223], v3 offset:44544
    s_waitcnt vmcnt(12) lgkmcnt(6)
    v_mfma_f32_32x32x16_bf16 v[160:175], v[208:211], v[108:111], v[160:175]
    ds_read_b64_tr_b16 v[208:209], v4 offset:45056
    ds_read_b64_tr_b16 v[210:211], v4 offset:45568
    s_waitcnt lgkmcnt(6)
    v_mfma_f32_32x32x16_bf16 v[176:191], v[212:215], v[108:111], v[176:191]
    ds_read_b64_tr_b16 v[212:213], v4 offset:16384
    ds_read_b64_tr_b16 v[214:215], v4 offset:16896
    s_waitcnt lgkmcnt(6)
    v_mfma_f32_32x32x16_bf16 v[192:207], v[216:219], v[108:111], v[192:207]
    ds_read_b64_tr_b16 v[216:217], v3 offset:16384
    ds_read_b64_tr_b16 v[218:219], v3 offset:16896
    s_waitcnt lgkmcnt(6)
    v_mfma_f32_32x32x16_bf16 v[224:239], v[220:223], v[108:111], v[224:239]
    ds_read_b64_tr_b16 v[220:221], v3 offset:45056
    ds_read_b64_tr_b16 v[222:223], v3 offset:45568
    s_waitcnt vmcnt(11) lgkmcnt(6)
    v_mfma_f32_32x32x16_bf16 v[160:175], v[208:211], v[112:115], v[160:175]
    ds_read_b64_tr_b16 v[208:209], v4 offset:46080
    ds_read_b64_tr_b16 v[210:211], v4 offset:46592
    s_waitcnt lgkmcnt(6)
    v_mfma_f32_32x32x16_bf16 v[176:191], v[212:215], v[112:115], v[176:191]
    ds_read_b64_tr_b16 v[212:213], v4 offset:17408
    ds_read_b64_tr_b16 v[214:215], v4 offset:17920
    s_waitcnt lgkmcnt(6)
    v_mfma_f32_32x32x16_bf16 v[192:207], v[216:219], v[112:115], v[192:207]
    ds_read_b64_tr_b16 v[216:217], v3 offset:17408
    ds_read_b64_tr_b16 v[218:219], v3 offset:17920
    s_waitcnt lgkmcnt(6)
    v_mfma_f32_32x32x16_bf16 v[224:239], v[220:223], v[112:115], v[224:239]
    ds_read_b64_tr_b16 v[220:221], v3 offset:46080
    ds_read_b64_tr_b16 v[222:223], v3 offset:46592
    s_waitcnt vmcnt(10) lgkmcnt(6)
    v_mfma_f32_32x32x16_bf16 v[160:175], v[208:211], v[116:119], v[160:175]
    ds_read_b64_tr_b16 v[208:209], v4 offset:47104
    ds_read_b64_tr_b16 v[210:211], v4 offset:47616
    s_waitcnt lgkmcnt(6)
    v_mfma_f32_32x32x16_bf16 v[176:191], v[212:215], v[116:119], v[176:191]
    ds_read_b64_tr_b16 v[212:213], v4 offset:18432
    ds_read_b64_tr_b16 v[214:215], v4 offset:18944
    s_waitcnt lgkmcnt(6)
    v_mfma_f32_32x32x16_bf16 v[192:207], v[216:219], v[116:119], v[192:207]
    ds_read_b64_tr_b16 v[216:217], v3 offset:18432
    ds_read_b64_tr_b16 v[218:219], v3 offset:18944
    s_waitcnt lgkmcnt(6)
    v_mfma_f32_32x32x16_bf16 v[224:239], v[220:223], v[116:119], v[224:239]
    ds_read_b64_tr_b16 v[220:221], v3 offset:47104
    ds_read_b64_tr_b16 v[222:223], v3 offset:47616
    s_waitcnt vmcnt(9) lgkmcnt(6)
    v_mfma_f32_32x32x16_bf16 v[160:175], v[208:211], v[120:123], v[160:175]
    ds_read_b64_tr_b16 v[208:209], v4 offset:48128
    ds_read_b64_tr_b16 v[210:211], v4 offset:48640
    s_waitcnt lgkmcnt(6)
    v_mfma_f32_32x32x16_bf16 v[176:191], v[212:215], v[120:123], v[176:191]
    ds_read_b64_tr_b16 v[212:213], v4 offset:19456
    ds_read_b64_tr_b16 v[214:215], v4 offset:19968
    s_waitcnt lgkmcnt(6)
    v_mfma_f32_32x32x16_bf16 v[192:207], v[216:219], v[120:123], v[192:207]
    ds_read_b64_tr_b16 v[216:217], v3 offset:19456
    ds_read_b64_tr_b16 v[218:219], v3 offset:19968
    s_waitcnt lgkmcnt(6)
    v_mfma_f32_32x32x16_bf16 v[224:239], v[220:223], v[120:123], v[224:239]
    ds_read_b64_tr_b16 v[220:221], v3 offset:48128
    ds_read_b64_tr_b16 v[222:223], v3 offset:48640
    s_waitcnt vmcnt(8) lgkmcnt(6)
    v_mfma_f32_32x32x16_bf16 v[160:175], v[208:211], v[124:127], v[160:175]
    ds_read_b64_tr_b16 v[208:209], v4 offset:49152
    ds_read_b64_tr_b16 v[210:211], v4 offset:49664
    s_waitcnt lgkmcnt(6)
    v_mfma_f32_32x32x16_bf16 v[176:191], v[212:215], v[124:127], v[176:191]
    ds_read_b64_tr_b16 v[212:213], v4 offset:20480
    ds_read_b64_tr_b16 v[214:215], v4 offset:20992
    s_waitcnt lgkmcnt(6)
    v_mfma_f32_32x32x16_bf16 v[192:207], v[216:219], v[124:127], v[192:207]
    ds_read_b64_tr_b16 v[216:217], v3 offset:20480
    ds_read_b64_tr_b16 v[218:219], v3 offset:20992
    s_waitcnt lgkmcnt(6)
    v_mfma_f32_32x32x16_bf16 v[224:239], v[220:223], v[124:127], v[224:239]
    ds_read_b64_tr_b16 v[220:221], v3 offset:49152
    ds_read_b64_tr_b16 v[222:223], v3 offset:49664
    s_waitcnt vmcnt(7) lgkmcnt(6)
    v_mfma_f32_32x32x16_bf16 v[160:175], v[208:211], v[128:131], v[160:175]
    ds_read_b64_tr_b16 v[208:209], v4 offset:50176
    ds_read_b64_tr_b16 v[210:211], v4 offset:50688
    s_waitcnt lgkmcnt(6)
    v_mfma_f32_32x32x16_bf16 v[176:191], v[212:215], v[128:131], v[176:191]
    ds_read_b64_tr_b16 v[212:213], v4 offset:21504
    ds_read_b64_tr_b16 v[214:215], v4 offset:22016
    s_waitcnt lgkmcnt(6)
    v_mfma_f32_32x32x16_bf16 v[192:207], v[216:219], v[128:131], v[192:207]
    v_add_f32 v240, v240, v242
    v_add_f32 v241, v241, v243
    ds_read_b64_tr_b16 v[216:217], v3 offset:21504
    ds_read_b64_tr_b16 v[218:219], v3 offset:22016
    s_waitcnt lgkmcnt(6)
    v_mfma_f32_32x32x16_bf16 v[224:239], v[220:223], v[128:131], v[224:239]
    v_add_f32 v240, v240, v244
    v_add_f32 v241, v241, v245
    ds_read_b64_tr_b16 v[220:221], v3 offset:50176
    ds_read_b64_tr_b16 v[222:223], v3 offset:50688
    s_waitcnt vmcnt(6) lgkmcnt(6)
    v_mfma_f32_32x32x16_bf16 v[160:175], v[208:211], v[132:135], v[160:175]
    v_add_f32 v240, v240, v246
    v_add_f32 v241, v241, v247
    ds_read_b64_tr_b16 v[208:209], v4 offset:51200
    ds_read_b64_tr_b16 v[210:211], v4 offset:51712
    s_waitcnt lgkmcnt(6)
    v_mfma_f32_32x32x16_bf16 v[176:191], v[212:215], v[132:135], v[176:191]
    v_add_f32 v240, v240, v248
    v_add_f32 v241, v241, v249
    ds_read_b64_tr_b16 v[212:213], v4 offset:22528
    ds_read_b64_tr_b16 v[214:215], v4 offset:23040
    s_waitcnt lgkmcnt(6)
    v_mfma_f32_32x32x16_bf16 v[192:207], v[216:219], v[132:135], v[192:207]
    v_add_f32 v240, v240, v250
    v_add_f32 v241, v241, v251
    ds_read_b64_tr_b16 v[216:217], v3 offset:22528
    ds_read_b64_tr_b16 v[218:219], v3 offset:23040
    s_waitcnt lgkmcnt(6)
    v_mfma_f32_32x32x16_bf16 v[224:239], v[220:223], v[132:135], v[224:239]
    v_add_f32 v240, v240, v252
    v_add_f32 v241, v241, v253
    ds_read_b64_tr_b16 v[220:221], v3 offset:51200
    ds_read_b64_tr_b16 v[222:223], v3 offset:51712
    s_waitcnt vmcnt(5) lgkmcnt(6)
    v_mfma_f32_32x32x16_bf16 v[160:175], v[208:211], v[136:139], v[160:175]
    v_mov_b32 v242, v240
    s_nop 1
    v_permlane32_swap_b32 v240, v242
    ds_read_b64_tr_b16 v[208:209], v4 offset:52224
    ds_read_b64_tr_b16 v[210:211], v4 offset:52736
    s_waitcnt lgkmcnt(6)
    v_mfma_f32_32x32x16_bf16 v[176:191], v[212:215], v[136:139], v[176:191]
    v_add_f32 v240, v240, v242
    v_mov_b32 v243, v241
    ds_read_b64_tr_b16 v[212:213], v4 offset:23552
    ds_read_b64_tr_b16 v[214:215], v4 offset:24064
    s_waitcnt lgkmcnt(6)
    v_mfma_f32_32x32x16_bf16 v[192:207], v[216:219], v[136:139], v[192:207]
    v_permlane32_swap_b32 v241, v243
    v_add_f32 v241, v241, v243
    ds_read_b64_tr_b16 v[216:217], v3 offset:23552
    ds_read_b64_tr_b16 v[218:219], v3 offset:24064
    s_waitcnt lgkmcnt(6)
    v_mfma_f32_32x32x16_bf16 v[224:239], v[220:223], v[136:139], v[224:239]
    v_mul_f32 v245, 0xbb124925, v240
    v_mul_f32 v241, 0x3b124925, v241
    ds_read_b64_tr_b16 v[220:221], v3 offset:52224
    ds_read_b64_tr_b16 v[222:223], v3 offset:52736
    s_waitcnt vmcnt(4) lgkmcnt(6)
    v_mfma_f32_32x32x16_bf16 v[160:175], v[208:211], v[140:143], v[160:175]
    v_fma_f32 v241, v245, -v245, v241
    v_max_f32 v241, 0, v241
    ds_read_b64_tr_b16 v[208:209], v4 offset:53248
    ds_read_b64_tr_b16 v[210:211], v4 offset:53760
    s_waitcnt lgkmcnt(6)
    v_mfma_f32_32x32x16_bf16 v[176:191], v[212:215], v[140:143], v[176:191]
    v_add_f32 v242, 0x3727c5ac, v241
    v_rsq_f32 v8, v242
    ds_read_b64_tr_b16 v[212:213], v4 offset:24576
    ds_read_b64_tr_b16 v[214:215], v4 offset:25088
    s_waitcnt lgkmcnt(6)
    v_mfma_f32_32x32x16_bf16 v[192:207], v[216:219], v[140:143], v[192:207]
    v_mul_f32 v243, v8, v8
    v_mov_b32 v244, 0x3727c5ac
    ds_read_b64_tr_b16 v[216:217], v3 offset:24576
    ds_read_b64_tr_b16 v[218:219], v3 offset:25088
    s_waitcnt lgkmcnt(6)
    v_mfma_f32_32x32x16_bf16 v[224:239], v[220:223], v[140:143], v[224:239]
    v_fmac_f32 v244, v243, v241
    v_rsq_f32 v244, v244
    ds_read_b64_tr_b16 v[220:221], v3 offset:53248
    ds_read_b64_tr_b16 v[222:223], v3 offset:53760
    s_waitcnt vmcnt(3) lgkmcnt(6)
    v_mfma_f32_32x32x16_bf16 v[160:175], v[208:211], v[144:147], v[160:175]
    v_mul_f32 v8, v8, v244
    v_cvt_pk_bf16_f32 v20, v245, v245
    ds_read_b64_tr_b16 v[208:209], v4 offset:54272
    ds_read_b64_tr_b16 v[210:211], v4 offset:54784
    s_waitcnt lgkmcnt(6)
    v_mfma_f32_32x32x16_bf16 v[176:191], v[212:215], v[144:147], v[176:191]
    v_lshlrev_b32 v240, 16, v20
    v_sub_f32 v240, v245, v240
    ds_read_b64_tr_b16 v[212:213], v4 offset:25600
    ds_read_b64_tr_b16 v[214:215], v4 offset:26112
    s_waitcnt lgkmcnt(6)
    v_mfma_f32_32x32x16_bf16 v[192:207], v[216:219], v[144:147], v[192:207]
    v_cvt_pk_bf16_f32 v21, v240, v240
    v_rcp_f32 v240, v8
    ds_read_b64_tr_b16 v[216:217], v3 offset:25600
    ds_read_b64_tr_b16 v[218:219], v3 offset:26112
    s_waitcnt lgkmcnt(6)
    v_mfma_f32_32x32x16_bf16 v[224:239], v[220:223], v[144:147], v[224:239]
    v_cvt_pk_bf16_f32 v241, v240, v240
    v_lshlrev_b32 v241, 16, v241
    ds_read_b64_tr_b16 v[220:221], v3 offset:54272
    ds_read_b64_tr_b16 v[222:223], v3 offset:54784
    s_waitcnt vmcnt(2) lgkmcnt(6)
    v_mfma_f32_32x32x16_bf16 v[160:175], v[208:211], v[148:151], v[160:175]
    v_sub_f32 v241, v240, v241
    v_cvt_pk_bf16_f32 v22, v240, v241
    ds_read_b64_tr_b16 v[208:209], v4 offset:55296
    ds_read_b64_tr_b16 v[210:211], v4 offset:55808
    s_waitcnt lgkmcnt(6)
    v_mfma_f32_32x32x16_bf16 v[176:191], v[212:215], v[148:151], v[176:191]
    v_and_b32 v242, 0xffff0000, v22
    v_sub_f32 v242, v241, v242
    ds_read_b64_tr_b16 v[212:213], v4 offset:26624
    ds_read_b64_tr_b16 v[214:215], v4 offset:27136
    s_waitcnt lgkmcnt(6)
    v_mfma_f32_32x32x16_bf16 v[192:207], v[216:219], v[148:151], v[192:207]
    v_cvt_pk_bf16_f32 v23, v242, v10
    s_mov_b32 s58, 0
    ds_read_b64_tr_b16 v[216:217], v3 offset:26624
    ds_read_b64_tr_b16 v[218:219], v3 offset:27136
    s_waitcnt lgkmcnt(6)
    v_mfma_f32_32x32x16_bf16 v[224:239], v[220:223], v[148:151], v[224:239]
    s_mov_b32 s59, -1
    s_mov_b64 exec, s[58:59]
    v_mov_b32 v20, 0
    v_mov_b32 v21, 0
    v_mov_b32 v22, 0
    v_mov_b32 v23, 0
    s_mov_b64 exec, -1
    ds_read_b64_tr_b16 v[220:221], v3 offset:55296
    ds_read_b64_tr_b16 v[222:223], v3 offset:55808
    s_waitcnt vmcnt(1) lgkmcnt(6)
    v_mfma_f32_32x32x16_bf16 v[160:175], v[208:211], v[152:155], v[160:175]
    s_lshl_b32 s52, s46, 11
    s_add_u32 s52, s52, 114688
    ds_read_b64_tr_b16 v[208:209], v4 offset:56320
    ds_read_b64_tr_b16 v[210:211], v4 offset:56832
    s_waitcnt lgkmcnt(6)
    v_mfma_f32_32x32x16_bf16 v[176:191], v[212:215], v[152:155], v[176:191]
    v_add_u32 v240, s52, v2
    v_mul_f32 v242, 0xc0135761, v8
    ds_read_b64_tr_b16 v[212:213], v4 offset:27648
    ds_read_b64_tr_b16 v[214:215], v4 offset:28160
    s_waitcnt lgkmcnt(6)
    v_mfma_f32_32x32x16_bf16 v[192:207], v[216:219], v[152:155], v[192:207]
    v_mul_f32 v243, v8, v8
    v_mul_f32 v243, v243, v242
    ds_read_b64_tr_b16 v[216:217], v3 offset:27648
    ds_read_b64_tr_b16 v[218:219], v3 offset:28160
    s_waitcnt lgkmcnt(6)
    v_mfma_f32_32x32x16_bf16 v[224:239], v[220:223], v[152:155], v[224:239]
    v_mul_f32 v243, 0x3d372713, v243
    v_rcp_f32 v244, v8
    ds_read_b64_tr_b16 v[220:221], v3 offset:56320
    ds_read_b64_tr_b16 v[222:223], v3 offset:56832
    s_waitcnt vmcnt(0) lgkmcnt(6)
    v_mfma_f32_32x32x16_bf16 v[160:175], v[208:211], v[156:159], v[160:175]
    ds_read_b64_tr_b16 v[208:209], v5 offset:18432
    ds_read_b64_tr_b16 v[210:211], v5 offset:18944
    s_waitcnt lgkmcnt(6)
    v_mfma_f32_32x32x16_bf16 v[176:191], v[212:215], v[156:159], v[176:191]
    ds_read_b64_tr_b16 v[212:213], v5 offset:18688
    ds_read_b64_tr_b16 v[214:215], v5 offset:19200
    s_waitcnt lgkmcnt(6)
    v_mfma_f32_32x32x16_bf16 v[192:207], v[216:219], v[156:159], v[192:207]
    ds_read_b64_tr_b16 v[216:217], v5 offset:19456
    ds_read_b64_tr_b16 v[218:219], v5 offset:19968
    s_waitcnt lgkmcnt(6)
    v_mfma_f32_32x32x16_bf16 v[224:239], v[220:223], v[156:159], v[224:239]
    ds_read_b64_tr_b16 v[220:221], v5 offset:19712
    ds_read_b64_tr_b16 v[222:223], v5 offset:20224
    s_waitcnt lgkmcnt(6)
    v_mfma_f32_32x32x16_bf16 v[160:175], v[208:211], v[20:23], v[160:175]
    s_waitcnt lgkmcnt(4)
    v_mfma_f32_32x32x16_bf16 v[176:191], v[212:215], v[20:23], v[176:191]
    s_waitcnt lgkmcnt(2)
    v_mfma_f32_32x32x16_bf16 v[192:207], v[216:219], v[20:23], v[192:207]
    s_waitcnt lgkmcnt(0)
    v_mfma_f32_32x32x16_bf16 v[224:239], v[220:223], v[20:23], v[224:239]
    s_nop 5
    v_cvt_pk_bf16_f32 v246, v160, v161
    v_cvt_pk_bf16_f32 v247, v162, v163
    v_cvt_pk_bf16_f32 v248, v164, v165
    v_cvt_pk_bf16_f32 v249, v166, v167
    v_cvt_pk_bf16_f32 v250, v168, v169
    v_cvt_pk_bf16_f32 v251, v170, v171
    v_cvt_pk_bf16_f32 v252, v172, v173
    v_cvt_pk_bf16_f32 v253, v174, v175
    ds_write_b128 v240, v[246:249] offset:0
    ds_write_b128 v240, v[250:253] offset:1024
    v_cvt_pk_bf16_f32 v246, v176, v177
    v_cvt_pk_bf16_f32 v247, v178, v179
    v_cvt_pk_bf16_f32 v248, v180, v181
    v_cvt_pk_bf16_f32 v249, v182, v183
    v_cvt_pk_bf16_f32 v250, v184, v185
    v_cvt_pk_bf16_f32 v251, v186, v187
    v_cvt_pk_bf16_f32 v252, v188, v189
    v_cvt_pk_bf16_f32 v253, v190, v191
    ds_write_b128 v240, v[246:249] offset:8192
    ds_write_b128 v240, v[250:253] offset:9216
    s_waitcnt lgkmcnt(0)
    s_barrier
    v_mfma_f32_32x32x16_bf16 v[160:175], v[40:43], v[24:27], 0
    v_mfma_f32_32x32x16_bf16 v[160:175], v[44:47], v[28:31], v[160:175]
    v_mfma_f32_32x32x16_bf16 v[160:175], v[40:43], v[32:35], v[160:175]
    v_mfma_f32_32x32x16_bf16 v[160:175], v[44:47], v[36:39], v[160:175]
    v_mul_f32 v208, v192, v192
    v_mul_f32 v209, v193, v193
    v_mul_f32 v210, v194, v194
    v_mul_f32 v211, v195, v195
    v_mul_f32 v212, v196, v196
    v_mul_f32 v213, v197, v197
    v_mul_f32 v214, v198, v198
    v_mul_f32 v215, v199, v199
    v_mul_f32 v216, v200, v200
    v_mul_f32 v217, v201, v201
    v_mul_f32 v218, v202, v202
    v_mul_f32 v219, v203, v203
    v_mul_f32 v220, v204, v204
    v_mul_f32 v221, v205, v205
    v_mul_f32 v222, v206, v206
    v_mul_f32 v223, v207, v207
    v_fma_f32 v208, v208, v243, v242
    v_fma_f32 v209, v209, v243, v242
    v_fma_f32 v210, v210, v243, v242
    v_fma_f32 v211, v211, v243, v242
    v_fma_f32 v212, v212, v243, v242
    v_fma_f32 v213, v213, v243, v242
    v_fma_f32 v214, v214, v243, v242
    v_fma_f32 v215, v215, v243, v242
    v_fma_f32 v216, v216, v243, v242
    v_fma_f32 v217, v217, v243, v242
    v_fma_f32 v218, v218, v243, v242
    v_fma_f32 v219, v219, v243, v242
    v_fma_f32 v220, v220, v243, v242
    v_fma_f32 v221, v221, v243, v242
    v_fma_f32 v222, v222, v243, v242
    v_fma_f32 v223, v223, v243, v242
    v_mul_f32 v208, v208, v192
    v_mul_f32 v209, v209, v193
    v_mul_f32 v210, v210, v194
    v_mul_f32 v211, v211, v195
    v_mul_f32 v212, v212, v196
    v_mul_f32 v213, v213, v197
    v_mul_f32 v214, v214, v198
    v_mul_f32 v215, v215, v199
    v_mul_f32 v216, v216, v200
    v_mul_f32 v217, v217, v201
    v_mul_f32 v218, v218, v202
    v_mul_f32 v219, v219, v203
    v_mul_f32 v220, v220, v204
    v_mul_f32 v221, v221, v205
    v_mul_f32 v222, v222, v206
    v_mul_f32 v223, v223, v207
    v_exp_f32 v208, v208
    v_exp_f32 v209, v209
    v_exp_f32 v210, v210
    v_exp_f32 v211, v211
    v_exp_f32 v212, v212
    v_exp_f32 v213, v213
    v_exp_f32 v214, v214
    v_exp_f32 v215, v215
    v_exp_f32 v216, v216
    v_exp_f32 v217, v217
    v_exp_f32 v218, v218
    v_exp_f32 v219, v219
    v_exp_f32 v220, v220
    v_exp_f32 v221, v221
    v_exp_f32 v222, v222
    v_exp_f32 v223, v223
    v_fma_f32 v208, v208, v244, v244
    v_fma_f32 v209, v209, v244, v244
    v_fma_f32 v210, v210, v244, v244
    v_fma_f32 v211, v211, v244, v244
    v_fma_f32 v212, v212, v244, v244
    v_fma_f32 v213, v213, v244, v244
    v_fma_f32 v214, v214, v244, v244
    v_fma_f32 v215, v215, v244, v244
    v_fma_f32 v216, v216, v244, v244
    v_fma_f32 v217, v217, v244, v244
    v_fma_f32 v218, v218, v244, v244
    v_fma_f32 v219, v219, v244, v244
    v_fma_f32 v220, v220, v244, v244
    v_fma_f32 v221, v221, v244, v244
    v_fma_f32 v222, v222, v244, v244
    v_fma_f32 v223, v223, v244, v244
    v_rcp_f32 v208, v208
    v_rcp_f32 v209, v209
    v_rcp_f32 v210, v210
    v_rcp_f32 v211, v211
    v_rcp_f32 v212, v212
    v_rcp_f32 v213, v213
    v_rcp_f32 v214, v214
    v_rcp_f32 v215, v215
    v_rcp_f32 v216, v216
    v_rcp_f32 v217, v217
    v_rcp_f32 v218, v218
    v_rcp_f32 v219, v219
    v_rcp_f32 v220, v220
    v_rcp_f32 v221, v221
    v_rcp_f32 v222, v222
    v_rcp_f32 v223, v223
    v_mul_f32 v192, v192, v208
    v_mul_f32 v193, v193, v209
    v_mul_f32 v194, v194, v210
    v_mul_f32 v195, v195, v211
    v_mul_f32 v196, v196, v212
    v_mul_f32 v197, v197, v213
    v_mul_f32 v198, v198, v214
    v_mul_f32 v199, v199, v215
    v_mul_f32 v200, v200, v216
    v_mul_f32 v201, v201, v217
    v_mul_f32 v202, v202, v218
    v_mul_f32 v203, v203, v219
    v_mul_f32 v204, v204, v220
    v_mul_f32 v205, v205, v221
    v_mul_f32 v206, v206, v222
    v_mul_f32 v207, v207, v223
    v_cvt_pk_bf16_f32 v192, v192, v193
    v_cvt_pk_bf16_f32 v193, v194, v195
    v_cvt_pk_bf16_f32 v194, v196, v197
    v_cvt_pk_bf16_f32 v195, v198, v199
    v_cvt_pk_bf16_f32 v196, v200, v201
    v_cvt_pk_bf16_f32 v197, v202, v203
    v_cvt_pk_bf16_f32 v198, v204, v205
    v_cvt_pk_bf16_f32 v199, v206, v207
    s_lshl_b32 s53, s45, 13
    s_add_u32 s53, s53, s48
    s_add_u32 s53, s53, 98304
    s_cmp_eq_u32 s94, 1
    s_cbranch_scc1 L_msl7
    buffer_store_dwordx4 v[192:195], v2, s[8:11], s53 offen sc1
    buffer_store_dwordx4 v[196:199], v2, s[8:11], s53 offen offset:1024 sc1
    s_branch L_mse7
L_msl7:
    buffer_store_dwordx4 v[192:195], v2, s[8:11], s53 offen
    buffer_store_dwordx4 v[196:199], v2, s[8:11], s53 offen offset:1024
L_mse7:
    v_mul_f32 v208, v224, v224
    v_mul_f32 v209, v225, v225
    v_mul_f32 v210, v226, v226
    v_mul_f32 v211, v227, v227
    v_mul_f32 v212, v228, v228
    v_mul_f32 v213, v229, v229
    v_mul_f32 v214, v230, v230
    v_mul_f32 v215, v231, v231
    v_mul_f32 v216, v232, v232
    v_mul_f32 v217, v233, v233
    v_mul_f32 v218, v234, v234
    v_mul_f32 v219, v235, v235
    v_mul_f32 v220, v236, v236
    v_mul_f32 v221, v237, v237
    v_mul_f32 v222, v238, v238
    v_mul_f32 v223, v239, v239
    v_fma_f32 v208, v208, v243, v242
    v_fma_f32 v209, v209, v243, v242
    v_fma_f32 v210, v210, v243, v242
    v_fma_f32 v211, v211, v243, v242
    v_fma_f32 v212, v212, v243, v242
    v_fma_f32 v213, v213, v243, v242
    v_fma_f32 v214, v214, v243, v242
    v_fma_f32 v215, v215, v243, v242
    v_fma_f32 v216, v216, v243, v242
    v_fma_f32 v217, v217, v243, v242
    v_fma_f32 v218, v218, v243, v242
    v_fma_f32 v219, v219, v243, v242
    v_fma_f32 v220, v220, v243, v242
    v_fma_f32 v221, v221, v243, v242
    s_waitcnt vmcnt(0)
    s_lshl_b32 s54, s45, 2
    s_add_u32 s54, s54, s49
    s_mov_b64 exec, 1
    s_cmp_eq_u32 s61, 1
    s_cbranch_scc1 L_msl8
    buffer_store_dword v9, v10, s[8:11], s54 offen offset:384 sc1
    s_branch L_mse8
L_msl8:
    buffer_store_dword v9, v10, s[8:11], s54 offen offset:384
L_mse8:
    s_mov_b64 exec, -1
    v_fma_f32 v222, v222, v243, v242
    v_fma_f32 v223, v223, v243, v242
    v_mul_f32 v208, v208, v224
    v_mul_f32 v209, v209, v225
    v_mul_f32 v210, v210, v226
    v_mul_f32 v211, v211, v227
    v_mul_f32 v212, v212, v228
    v_mul_f32 v213, v213, v229
    v_mul_f32 v214, v214, v230
    v_mul_f32 v215, v215, v231
    v_mul_f32 v216, v216, v232
    v_mul_f32 v217, v217, v233
    v_mul_f32 v218, v218, v234
    v_mul_f32 v219, v219, v235
    v_mul_f32 v220, v220, v236
    v_mul_f32 v221, v221, v237
    v_mul_f32 v222, v222, v238
    v_mul_f32 v223, v223, v239
    v_exp_f32 v208, v208
    v_exp_f32 v209, v209
    v_exp_f32 v210, v210
    v_exp_f32 v211, v211
    v_exp_f32 v212, v212
    v_exp_f32 v213, v213
    v_exp_f32 v214, v214
    buffer_load_dword v241, v7, s[8:11], s49 offen offset:384 sc1
    v_exp_f32 v215, v215
    v_exp_f32 v216, v216
    v_exp_f32 v217, v217
    v_exp_f32 v218, v218
    v_exp_f32 v219, v219
    v_exp_f32 v220, v220
    v_exp_f32 v221, v221
    v_exp_f32 v222, v222
    v_exp_f32 v223, v223
    v_fma_f32 v208, v208, v244, v244
    v_fma_f32 v209, v209, v244, v244
    v_fma_f32 v210, v210, v244, v244
    v_fma_f32 v211, v211, v244, v244
    v_fma_f32 v212, v212, v244, v244
    v_fma_f32 v213, v213, v244, v244
    v_fma_f32 v214, v214, v244, v244
    v_fma_f32 v215, v215, v244, v244
    v_fma_f32 v216, v216, v244, v244
    v_fma_f32 v217, v217, v244, v244
    v_fma_f32 v218, v218, v244, v244
    v_fma_f32 v219, v219, v244, v244
    v_fma_f32 v220, v220, v244, v244
    v_fma_f32 v221, v221, v244, v244
    v_fma_f32 v222, v222, v244, v244
    v_fma_f32 v223, v223, v244, v244
    s_waitcnt vmcnt(0)
    v_cmp_eq_u32 vcc, 0, v241
    s_nop 1
    s_and_b32 s57, vcc_lo, s74
    s_cbranch_scc0 L_apok4
    s_mov_b32 s51, 0
L_ap4:
    buffer_load_dword v241, v7, s[8:11], s49 offen offset:384 sc1
    s_add_u32 s51, s51, 1
    s_cmp_gt_u32 s51, 0x40000
    s_cbranch_scc1 L_end
    s_waitcnt vmcnt(0)
    v_cmp_eq_u32 vcc, 0, v241
    s_nop 1
    s_and_b32 s57, vcc_lo, s74
    s_cbranch_scc1 L_ap4
L_apok4:
    buffer_load_dwordx4 v[48:51], v13, s[8:11], s66 offen offset:0 sc1
    v_rcp_f32 v208, v208
    v_rcp_f32 v209, v209
    v_rcp_f32 v210, v210
    buffer_load_dwordx4 v[52:55], v13, s[8:11], s66 offen offset:1024 sc1
    v_rcp_f32 v211, v211
    v_rcp_f32 v212, v212
    v_rcp_f32 v213, v213
    buffer_load_dwordx4 v[56:59], v13, s[8:11], s67 offen offset:0 sc1
    v_rcp_f32 v214, v214
    v_rcp_f32 v215, v215
    v_rcp_f32 v216, v216
    buffer_load_dwordx4 v[60:63], v13, s[8:11], s67 offen offset:1024 sc1
    v_rcp_f32 v217, v217
    v_rcp_f32 v218, v218
    v_rcp_f32 v219, v219
    buffer_load_dwordx4 v[64:67], v13, s[8:11], s68 offen offset:0 sc1
    v_rcp_f32 v220, v220
    v_rcp_f32 v221, v221
    v_rcp_f32 v222, v222
    buffer_load_dwordx4 v[68:71], v13, s[8:11], s68 offen offset:1024 sc1
    v_rcp_f32 v223, v223
    v_mul_f32 v224, v224, v208
    v_mul_f32 v225, v225, v209
    buffer_load_dwordx4 v[72:75], v13, s[8:11], s69 offen offset:0 sc1
    v_mul_f32 v226, v226, v210
    v_mul_f32 v227, v227, v211
    v_mul_f32 v228, v228, v212
    buffer_load_dwordx4 v[76:79], v13, s[8:11], s69 offen offset:1024 sc1
    v_mul_f32 v229, v229, v213
    v_mul_f32 v230, v230, v214
    v_mul_f32 v231, v231, v215
    buffer_load_dwordx4 v[80:83], v13, s[8:11], s70 offen offset:0 sc1
    v_mul_f32 v232, v232, v216
    v_mul_f32 v233, v233, v217
    v_mul_f32 v234, v234, v218
    buffer_load_dwordx4 v[84:87], v13, s[8:11], s70 offen offset:1024 sc1
    v_mul_f32 v235, v235, v219
    v_mul_f32 v236, v236, v220
    v_mul_f32 v237, v237, v221
    buffer_load_dwordx4 v[88:91], v13, s[8:11], s71 offen offset:0 sc1
    v_mul_f32 v238, v238, v222
    v_mul_f32 v239, v239, v223
    v_cvt_pk_bf16_f32 v224, v224, v225
    buffer_load_dwordx4 v[92:95], v13, s[8:11], s71 offen offset:1024 sc1
    v_cvt_pk_bf16_f32 v225, v226, v227
    v_cvt_pk_bf16_f32 v226, v228, v229
    v_cvt_pk_bf16_f32 v227, v230, v231
    v_cvt_pk_bf16_f32 v228, v232, v233
    v_cvt_pk_bf16_f32 v229, v234, v235
    v_cvt_pk_bf16_f32 v230, v236, v237
    v_cvt_pk_bf16_f32 v231, v238, v239
    s_lshl_b32 s53, s45, 13
    s_add_u32 s53, s53, s48
    s_add_u32 s53, s53, 100352
    s_cmp_eq_u32 s94, 1
    s_cbranch_scc1 L_msl9
    buffer_store_dwordx4 v[224:227], v2, s[8:11], s53 offen sc1
    buffer_store_dwordx4 v[228:231], v2, s[8:11], s53 offen offset:1024 sc1
    s_branch L_mse9
L_msl9:
    buffer_store_dwordx4 v[224:227], v2, s[8:11], s53 offen
    buffer_store_dwordx4 v[228:231], v2, s[8:11], s53 offen offset:1024
L_mse9:
    buffer_load_dword v241, v7, s[8:11], s49 offen offset:256 sc1
    s_barrier
    ds_read_b128 v[176:179], v240 offset:0
    ds_read_b128 v[180:183], v240 offset:1024
    ds_read_b64_tr_b16 v[208:209], v4 offset:28672
    ds_read_b64_tr_b16 v[210:211], v4 offset:29184
    ds_read_b64_tr_b16 v[212:213], v4 offset:29696
    ds_read_b64_tr_b16 v[214:215], v4 offset:30208
    ds_read_b64_tr_b16 v[216:217], v4 offset:30720
    ds_read_b64_tr_b16 v[218:219], v4 offset:31232
    ds_read_b64_tr_b16 v[220:221], v4 offset:31744
    ds_read_b64_tr_b16 v[222:223], v4 offset:32256
    s_waitcnt lgkmcnt(6)
    v_mfma_f32_32x32x16_bf16 v[160:175], v[208:211], v[192:195], v[160:175]
    ds_read_b64_tr_b16 v[208:209], v4 offset:32768
    ds_read_b64_tr_b16 v[210:211], v4 offset:33280
    s_waitcnt lgkmcnt(6)
    v_mfma_f32_32x32x16_bf16 v[144:159], v[212:215], v[192:195], 0
    ds_read_b64_tr_b16 v[212:213], v4 offset:33792
    ds_read_b64_tr_b16 v[214:215], v4 offset:34304
    s_waitcnt lgkmcnt(6)
    v_mfma_f32_32x32x16_bf16 v[160:175], v[216:219], v[196:199], v[160:175]
    ds_read_b64_tr_b16 v[216:217], v4 offset:34816
    ds_read_b64_tr_b16 v[218:219], v4 offset:35328
    s_waitcnt lgkmcnt(6)
    v_mfma_f32_32x32x16_bf16 v[144:159], v[220:223], v[196:199], v[144:159]
    s_waitcnt vmcnt(0)
    s_lshl_b32 s54, s45, 2
    s_add_u32 s54, s54, s49
    s_mov_b64 exec, 1
    s_cmp_eq_u32 s61, 1
    s_cbranch_scc1 L_msl10
    buffer_store_dword v9, v10, s[8:11], s54 offen offset:448 sc1
    s_branch L_mse10
L_msl10:
    buffer_store_dword v9, v10, s[8:11], s54 offen offset:448
L_mse10:
    s_mov_b64 exec, -1
    v_cmp_eq_u32 vcc, 0, v241
    s_nop 1
    s_and_b32 s57, vcc_lo, s74
    s_cbranch_scc0 L_apok5
    s_mov_b32 s51, 0
L_ap5:
    buffer_load_dword v241, v7, s[8:11], s49 offen offset:256 sc1
    s_add_u32 s51, s51, 1
    s_cmp_gt_u32 s51, 0x40000
    s_cbranch_scc1 L_end
    s_waitcnt vmcnt(0)
    v_cmp_eq_u32 vcc, 0, v241
    s_nop 1
    s_and_b32 s57, vcc_lo, s74
    s_cbranch_scc1 L_ap5
L_apok5:
    ds_read_b64_tr_b16 v[220:221], v4 offset:35840
    ds_read_b64_tr_b16 v[222:223], v4 offset:36352
    s_waitcnt lgkmcnt(6)
    v_mfma_f32_32x32x16_bf16 v[160:175], v[208:211], v[48:51], v[160:175]
    buffer_load_dwordx4 v[96:99], v2, s[8:11], s66 offen offset:0 sc1
    ds_read_b64_tr_b16 v[208:209], v4 offset:36864
    ds_read_b64_tr_b16 v[210:211], v4 offset:37376
    s_waitcnt lgkmcnt(6)
    v_mfma_f32_32x32x16_bf16 v[144:159], v[212:215], v[48:51], v[144:159]
    buffer_load_dwordx4 v[100:103], v2, s[8:11], s66 offen offset:1024 sc1
    ds_read_b64_tr_b16 v[212:213], v4 offset:37888
    ds_read_b64_tr_b16 v[214:215], v4 offset:38400
    s_waitcnt lgkmcnt(6)
    v_mfma_f32_32x32x16_bf16 v[160:175], v[216:219], v[52:55], v[160:175]
    ds_read_b64_tr_b16 v[216:217], v4 offset:38912
    ds_read_b64_tr_b16 v[218:219], v4 offset:39424
    s_waitcnt lgkmcnt(6)
    v_mfma_f32_32x32x16_bf16 v[144:159], v[220:223], v[52:55], v[144:159]
    buffer_load_dwordx4 v[104:107], v2, s[8:11], s67 offen offset:0 sc1
    ds_read_b64_tr_b16 v[220:221], v4 offset:39936
    ds_read_b64_tr_b16 v[222:223], v4 offset:40448
    s_waitcnt lgkmcnt(6)
    v_mfma_f32_32x32x16_bf16 v[160:175], v[208:211], v[56:59], v[160:175]
    ds_read_b64_tr_b16 v[208:209], v4 offset:40960
    ds_read_b64_tr_b16 v[210:211], v4 offset:41472
    s_waitcnt lgkmcnt(6)
    v_mfma_f32_32x32x16_bf16 v[144:159], v[212:215], v[56:59], v[144:159]
    buffer_load_dwordx4 v[108:111], v2, s[8:11], s67 offen offset:1024 sc1
    ds_read_b64_tr_b16 v[212:213], v4 offset:41984
    ds_read_b64_tr_b16 v[214:215], v4 offset:42496
    s_waitcnt lgkmcnt(6)
    v_mfma_f32_32x32x16_bf16 v[160:175], v[216:219], v[60:63], v[160:175]
    ds_read_b64_tr_b16 v[216:217], v4 offset:43008
    ds_read_b64_tr_b16 v[218:219], v4 offset:43520
    s_waitcnt lgkmcnt(6)
    v_mfma_f32_32x32x16_bf16 v[144:159], v[220:223], v[60:63], v[144:159]
    buffer_load_dwordx4 v[112:115], v2, s[8:11], s68 offen offset:0 sc1
    ds_read_b64_tr_b16 v[220:221], v4 offset:44032
    ds_read_b64_tr_b16 v[222:223], v4 offset:44544
    s_waitcnt lgkmcnt(6)
    v_mfma_f32_32x32x16_bf16 v[160:175], v[208:211], v[64:67], v[160:175]
    ds_read_b64_tr_b16 v[208:209], v4 offset:45056
    ds_read_b64_tr_b16 v[210:211], v4 offset:45568
    s_waitcnt lgkmcnt(6)
    v_mfma_f32_32x32x16_bf16 v[144:159], v[212:215], v[64:67], v[144:159]
    buffer_load_dwordx4 v[116:119], v2, s[8:11], s68 offen offset:1024 sc1
    ds_read_b64_tr_b16 v[212:213], v4 offset:46080
    ds_read_b64_tr_b16 v[214:215], v4 offset:46592
    s_waitcnt lgkmcnt(6)
    v_mfma_f32_32x32x16_bf16 v[160:175], v[216:219], v[68:71], v[160:175]
    ds_read_b64_tr_b16 v[216:217], v4 offset:47104
    ds_read_b64_tr_b16 v[218:219], v4 offset:47616
    s_waitcnt lgkmcnt(6)
    v_mfma_f32_32x32x16_bf16 v[144:159], v[220:223], v[68:71], v[144:159]
    buffer_load_dwordx4 v[120:123], v2, s[8:11], s69 offen offset:0 sc1
    ds_read_b64_tr_b16 v[220:221], v4 offset:48128
    ds_read_b64_tr_b16 v[222:223], v4 offset:48640
    s_waitcnt lgkmcnt(6)
    v_mfma_f32_32x32x16_bf16 v[160:175], v[208:211], v[72:75], v[160:175]
    ds_read_b64_tr_b16 v[208:209], v4 offset:49152
    ds_read_b64_tr_b16 v[210:211], v4 offset:49664
    s_waitcnt lgkmcnt(6)
    v_mfma_f32_32x32x16_bf16 v[144:159], v[212:215], v[72:75], v[144:159]
    buffer_load_dwordx4 v[124:127], v2, s[8:11], s69 offen offset:1024 sc1
    ds_read_b64_tr_b16 v[212:213], v4 offset:50176
    ds_read_b64_tr_b16 v[214:215], v4 offset:50688
    s_waitcnt lgkmcnt(6)
    v_mfma_f32_32x32x16_bf16 v[160:175], v[216:219], v[76:79], v[160:175]
    ds_read_b64_tr_b16 v[216:217], v4 offset:51200
    ds_read_b64_tr_b16 v[218:219], v4 offset:51712
    s_waitcnt lgkmcnt(6)
    v_mfma_f32_32x32x16_bf16 v[144:159], v[220:223], v[76:79], v[144:159]
    buffer_load_dwordx4 v[128:131], v2, s[8:11], s70 offen offset:0 sc1
    ds_read_b64_tr_b16 v[220:221], v4 offset:52224
    ds_read_b64_tr_b16 v[222:223], v4 offset:52736
    s_waitcnt lgkmcnt(6)
    v_mfma_f32_32x32x16_bf16 v[160:175], v[208:211], v[80:83], v[160:175]
    ds_read_b64_tr_b16 v[208:209], v4 offset:53248
    ds_read_b64_tr_b16 v[210:211], v4 offset:53760
    s_waitcnt lgkmcnt(6)
    v_mfma_f32_32x32x16_bf16 v[144:159], v[212:215], v[80:83], v[144:159]
    buffer_load_dwordx4 v[132:135], v2, s[8:11], s70 offen offset:1024 sc1
    ds_read_b64_tr_b16 v[212:213], v4 offset:54272
    ds_read_b64_tr_b16 v[214:215], v4 offset:54784
    s_waitcnt lgkmcnt(6)
    v_mfma_f32_32x32x16_bf16 v[160:175], v[216:219], v[84:87], v[160:175]
    ds_read_b64_tr_b16 v[216:217], v4 offset:55296
    ds_read_b64_tr_b16 v[218:219], v4 offset:55808
    s_waitcnt lgkmcnt(6)
    v_mfma_f32_32x32x16_bf16 v[144:159], v[220:223], v[84:87], v[144:159]
    buffer_load_dwordx4 v[136:139], v2, s[8:11], s71 offen offset:0 sc1
    ds_read_b64_tr_b16 v[220:221], v4 offset:56320
    ds_read_b64_tr_b16 v[222:223], v4 offset:56832
    s_waitcnt lgkmcnt(6)
    v_mfma_f32_32x32x16_bf16 v[160:175], v[208:211], v[88:91], v[160:175]
    s_waitcnt lgkmcnt(4)
    v_mfma_f32_32x32x16_bf16 v[144:159], v[212:215], v[88:91], v[144:159]
    buffer_load_dwordx4 v[140:143], v2, s[8:11], s71 offen offset:1024 sc1
    s_waitcnt lgkmcnt(2)
    v_mfma_f32_32x32x16_bf16 v[160:175], v[216:219], v[92:95], v[160:175]
    s_waitcnt lgkmcnt(0)
    v_mfma_f32_32x32x16_bf16 v[144:159], v[220:223], v[92:95], v[144:159]
    buffer_load_dword v241, v7, s[8:11], s49 offen offset:448 sc1
    ds_read_b64_tr_b16 v[208:209], v4 offset:0
    ds_read_b64_tr_b16 v[210:211], v4 offset:512
    ds_read_b64_tr_b16 v[212:213], v4 offset:1024
    ds_read_b64_tr_b16 v[214:215], v4 offset:1536
    ds_read_b64_tr_b16 v[216:217], v4 offset:2048
    ds_read_b64_tr_b16 v[218:219], v4 offset:2560
    ds_read_b64_tr_b16 v[220:221], v4 offset:3072
    ds_read_b64_tr_b16 v[222:223], v4 offset:3584
    s_waitcnt lgkmcnt(6)
    v_mfma_f32_32x32x16_bf16 v[160:175], v[208:211], v[176:179], v[160:175]
    ds_read_b64_tr_b16 v[208:209], v4 offset:4096
    ds_read_b64_tr_b16 v[210:211], v4 offset:4608
    s_waitcnt lgkmcnt(6)
    v_mfma_f32_32x32x16_bf16 v[144:159], v[212:215], v[176:179], v[144:159]
    ds_read_b64_tr_b16 v[212:213], v4 offset:5120
    ds_read_b64_tr_b16 v[214:215], v4 offset:5632
    s_waitcnt lgkmcnt(6)
    v_mfma_f32_32x32x16_bf16 v[160:175], v[216:219], v[180:183], v[160:175]
    ds_read_b64_tr_b16 v[216:217], v4 offset:6144
    ds_read_b64_tr_b16 v[218:219], v4 offset:6656
    s_waitcnt lgkmcnt(6)
    v_mfma_f32_32x32x16_bf16 v[144:159], v[220:223], v[180:183], v[144:159]
    ds_read_b64_tr_b16 v[220:221], v4 offset:7168
    ds_read_b64_tr_b16 v[222:223], v4 offset:7680
    s_waitcnt vmcnt(12) lgkmcnt(6)
    v_mfma_f32_32x32x16_bf16 v[160:175], v[208:211], v[96:99], v[160:175]
    ds_read_b64_tr_b16 v[208:209], v4 offset:8192
    ds_read_b64_tr_b16 v[210:211], v4 offset:8704
    s_waitcnt lgkmcnt(6)
    v_mfma_f32_32x32x16_bf16 v[144:159], v[212:215], v[96:99], v[144:159]
    ds_read_b64_tr_b16 v[212:213], v4 offset:9216
    ds_read_b64_tr_b16 v[214:215], v4 offset:9728
    s_waitcnt vmcnt(11) lgkmcnt(6)
    v_mfma_f32_32x32x16_bf16 v[160:175], v[216:219], v[100:103], v[160:175]
    s_waitcnt vmcnt(0)
    v_cmp_eq_u32 vcc, 0, v241
    s_nop 1
    s_and_b32 s57, vcc_lo, s74
    s_cbranch_scc0 L_apok6
    s_mov_b32 s51, 0
L_ap6:
    buffer_load_dword v241, v7, s[8:11], s49 offen offset:448 sc1
    s_add_u32 s51, s51, 1
    s_cmp_gt_u32 s51, 0x40000
    s_cbranch_scc1 L_end
    s_waitcnt vmcnt(0)
    v_cmp_eq_u32 vcc, 0, v241
    s_nop 1
    s_and_b32 s57, vcc_lo, s74
    s_cbranch_scc1 L_ap6
L_apok6:
    ds_read_b64_tr_b16 v[216:217], v4 offset:10240
    ds_read_b64_tr_b16 v[218:219], v4 offset:10752
    s_waitcnt lgkmcnt(6)
    v_mfma_f32_32x32x16_bf16 v[144:159], v[220:223], v[100:103], v[144:159]
    buffer_load_dwordx4 v[48:51], v13, s[8:11], s66 offen offset:2048 sc1
    ds_read_b64_tr_b16 v[220:221], v4 offset:11264
    ds_read_b64_tr_b16 v[222:223], v4 offset:11776
    s_waitcnt lgkmcnt(6)
    v_mfma_f32_32x32x16_bf16 v[160:175], v[208:211], v[104:107], v[160:175]
    buffer_load_dwordx4 v[52:55], v13, s[8:11], s66 offen offset:3072 sc1
    ds_read_b64_tr_b16 v[208:209], v4 offset:12288
    ds_read_b64_tr_b16 v[210:211], v4 offset:12800
    s_waitcnt lgkmcnt(6)
    v_mfma_f32_32x32x16_bf16 v[144:159], v[212:215], v[104:107], v[144:159]
    ds_read_b64_tr_b16 v[212:213], v4 offset:13312
    ds_read_b64_tr_b16 v[214:215], v4 offset:13824
    s_waitcnt lgkmcnt(6)
    v_mfma_f32_32x32x16_bf16 v[160:175], v[216:219], v[108:111], v[160:175]
    buffer_load_dwordx4 v[56:59], v13, s[8:11], s67 offen offset:2048 sc1
    ds_read_b64_tr_b16 v[216:217], v4 offset:14336
    ds_read_b64_tr_b16 v[218:219], v4 offset:14848
    s_waitcnt lgkmcnt(6)
    v_mfma_f32_32x32x16_bf16 v[144:159], v[220:223], v[108:111], v[144:159]
    ds_read_b64_tr_b16 v[220:221], v4 offset:15360
    ds_read_b64_tr_b16 v[222:223], v4 offset:15872
    s_waitcnt lgkmcnt(6)
    v_mfma_f32_32x32x16_bf16 v[160:175], v[208:211], v[112:115], v[160:175]
    buffer_load_dwordx4 v[60:63], v13, s[8:11], s67 offen offset:3072 sc1
    ds_read_b64_tr_b16 v[208:209], v4 offset:16384
    ds_read_b64_tr_b16 v[210:211], v4 offset:16896
    s_waitcnt lgkmcnt(6)
    v_mfma_f32_32x32x16_bf16 v[144:159], v[212:215], v[112:115], v[144:159]
    buffer_load_dwordx4 v[64:67], v13, s[8:11], s68 offen offset:2048 sc1
    ds_read_b64_tr_b16 v[212:213], v4 offset:17408
    ds_read_b64_tr_b16 v[214:215], v4 offset:17920
    s_waitcnt lgkmcnt(6)
    v_mfma_f32_32x32x16_bf16 v[160:175], v[216:219], v[116:119], v[160:175]
    ds_read_b64_tr_b16 v[216:217], v4 offset:18432
    ds_read_b64_tr_b16 v[218:219], v4 offset:18944
    s_waitcnt lgkmcnt(6)
    v_mfma_f32_32x32x16_bf16 v[144:159], v[220:223], v[116:119], v[144:159]
    buffer_load_dwordx4 v[68:71], v13, s[8:11], s68 offen offset:3072 sc1
    ds_read_b64_tr_b16 v[220:221], v4 offset:19456
    ds_read_b64_tr_b16 v[222:223], v4 offset:19968
    s_waitcnt lgkmcnt(6)
    v_mfma_f32_32x32x16_bf16 v[160:175], v[208:211], v[120:123], v[160:175]
    ds_read_b64_tr_b16 v[208:209], v4 offset:20480
    ds_read_b64_tr_b16 v[210:211], v4 offset:20992
    s_waitcnt lgkmcnt(6)
    v_mfma_f32_32x32x16_bf16 v[144:159], v[212:215], v[120:123], v[144:159]
    buffer_load_dwordx4 v[72:75], v13, s[8:11], s69 offen offset:2048 sc1
    ds_read_b64_tr_b16 v[212:213], v4 offset:21504
    ds_read_b64_tr_b16 v[214:215], v4 offset:22016
    s_waitcnt lgkmcnt(6)
    v_mfma_f32_32x32x16_bf16 v[160:175], v[216:219], v[124:127], v[160:175]
    buffer_load_dwordx4 v[76:79], v13, s[8:11], s69 offen offset:3072 sc1
    ds_read_b64_tr_b16 v[216:217], v4 offset:22528
    ds_read_b64_tr_b16 v[218:219], v4 offset:23040
    s_waitcnt lgkmcnt(6)
    v_mfma_f32_32x32x16_bf16 v[144:159], v[220:223], v[124:127], v[144:159]
    ds_read_b64_tr_b16 v[220:221], v4 offset:23552
    ds_read_b64_tr_b16 v[222:223], v4 offset:24064
    s_waitcnt lgkmcnt(6)
    v_mfma_f32_32x32x16_bf16 v[160:175], v[208:211], v[128:131], v[160:175]
    buffer_load_dwordx4 v[80:83], v13, s[8:11], s70 offen offset:2048 sc1
    ds_read_b64_tr_b16 v[208:209], v4 offset:24576
    ds_read_b64_tr_b16 v[210:211], v4 offset:25088
    s_waitcnt lgkmcnt(6)
    v_mfma_f32_32x32x16_bf16 v[144:159], v[212:215], v[128:131], v[144:159]
    ds_read_b64_tr_b16 v[212:213], v4 offset:25600
    ds_read_b64_tr_b16 v[214:215], v4 offset:26112
    s_waitcnt lgkmcnt(6)
    v_mfma_f32_32x32x16_bf16 v[160:175], v[216:219], v[132:135], v[160:175]
    buffer_load_dwordx4 v[84:87], v13, s[8:11], s70 offen offset:3072 sc1
    ds_read_b64_tr_b16 v[216:217], v4 offset:26624
    ds_read_b64_tr_b16 v[218:219], v4 offset:27136
    s_waitcnt lgkmcnt(6)
    v_mfma_f32_32x32x16_bf16 v[144:159], v[220:223], v[132:135], v[144:159]
    buffer_load_dwordx4 v[88:91], v13, s[8:11], s71 offen offset:2048 sc1
    ds_read_b64_tr_b16 v[220:221], v4 offset:27648
    ds_read_b64_tr_b16 v[222:223], v4 offset:28160
    s_waitcnt lgkmcnt(6)
    v_mfma_f32_32x32x16_bf16 v[160:175], v[208:211], v[136:139], v[160:175]
    s_waitcnt lgkmcnt(4)
    v_mfma_f32_32x32x16_bf16 v[144:159], v[212:215], v[136:139], v[144:159]
    buffer_load_dwordx4 v[92:95], v13, s[8:11], s71 offen offset:3072 sc1
    s_waitcnt lgkmcnt(2)
    v_mfma_f32_32x32x16_bf16 v[160:175], v[216:219], v[140:143], v[160:175]
    s_waitcnt lgkmcnt(0)
    v_mfma_f32_32x32x16_bf16 v[144:159], v[220:223], v[140:143], v[144:159]
    buffer_load_dword v241, v7, s[8:11], s49 offen offset:320 sc1
    s_barrier
    ds_read_b128 v[184:187], v240 offset:8192
    ds_read_b128 v[188:191], v240 offset:9216
    ds_read_b64_tr_b16 v[208:209], v3 offset:0
    ds_read_b64_tr_b16 v[210:211], v3 offset:512
    ds_read_b64_tr_b16 v[212:213], v3 offset:1024
    ds_read_b64_tr_b16 v[214:215], v3 offset:1536
    ds_read_b64_tr_b16 v[216:217], v3 offset:2048
    ds_read_b64_tr_b16 v[218:219], v3 offset:2560
    ds_read_b64_tr_b16 v[220:221], v3 offset:3072
    ds_read_b64_tr_b16 v[222:223], v3 offset:3584
    s_waitcnt lgkmcnt(6)
    v_mfma_f32_32x32x16_bf16 v[160:175], v[208:211], v[224:227], v[160:175]
    ds_read_b64_tr_b16 v[208:209], v3 offset:4096
    ds_read_b64_tr_b16 v[210:211], v3 offset:4608
    s_waitcnt lgkmcnt(6)
    v_mfma_f32_32x32x16_bf16 v[144:159], v[212:215], v[224:227], v[144:159]
    ds_read_b64_tr_b16 v[212:213], v3 offset:5120
    ds_read_b64_tr_b16 v[214:215], v3 offset:5632
    s_waitcnt lgkmcnt(6)
    v_mfma_f32_32x32x16_bf16 v[160:175], v[216:219], v[228:231], v[160:175]
    ds_read_b64_tr_b16 v[216:217], v3 offset:6144
    ds_read_b64_tr_b16 v[218:219], v3 offset:6656
    s_waitcnt lgkmcnt(6)
    v_mfma_f32_32x32x16_bf16 v[144:159], v[220:223], v[228:231], v[144:159]
    ds_read_b64_tr_b16 v[220:221], v3 offset:7168
    ds_read_b64_tr_b16 v[222:223], v3 offset:7680
    s_waitcnt vmcnt(12) lgkmcnt(6)
    v_mfma_f32_32x32x16_bf16 v[160:175], v[208:211], v[48:51], v[160:175]
    ds_read_b64_tr_b16 v[208:209], v3 offset:8192
    ds_read_b64_tr_b16 v[210:211], v3 offset:8704
    s_waitcnt lgkmcnt(6)
    v_mfma_f32_32x32x16_bf16 v[144:159], v[212:215], v[48:51], v[144:159]
    ds_read_b64_tr_b16 v[212:213], v3 offset:9216
    ds_read_b64_tr_b16 v[214:215], v3 offset:9728
    s_waitcnt vmcnt(11) lgkmcnt(6)
    v_mfma_f32_32x32x16_bf16 v[160:175], v[216:219], v[52:55], v[160:175]
    s_waitcnt vmcnt(0)
    v_cmp_eq_u32 vcc, 0, v241
    s_nop 1
    s_and_b32 s57, vcc_lo, s74
    s_cbranch_scc0 L_apok7
    s_mov_b32 s51, 0
L_ap7:
    buffer_load_dword v241, v7, s[8:11], s49 offen offset:320 sc1
    s_add_u32 s51, s51, 1
    s_cmp_gt_u32 s51, 0x40000
    s_cbranch_scc1 L_end
    s_waitcnt vmcnt(0)
    v_cmp_eq_u32 vcc, 0, v241
    s_nop 1
    s_and_b32 s57, vcc_lo, s74
    s_cbranch_scc1 L_ap7
L_apok7:
    ds_read_b64_tr_b16 v[216:217], v3 offset:10240
    ds_read_b64_tr_b16 v[218:219], v3 offset:10752
    s_waitcnt lgkmcnt(6)
    v_mfma_f32_32x32x16_bf16 v[144:159], v[220:223], v[52:55], v[144:159]
    buffer_load_dwordx4 v[96:99], v2, s[8:11], s66 offen offset:2048 sc1
    ds_read_b64_tr_b16 v[220:221], v3 offset:11264
    ds_read_b64_tr_b16 v[222:223], v3 offset:11776
    s_waitcnt lgkmcnt(6)
    v_mfma_f32_32x32x16_bf16 v[160:175], v[208:211], v[56:59], v[160:175]
    buffer_load_dwordx4 v[100:103], v2, s[8:11], s66 offen offset:3072 sc1
    ds_read_b64_tr_b16 v[208:209], v3 offset:12288
    ds_read_b64_tr_b16 v[210:211], v3 offset:12800
    s_waitcnt lgkmcnt(6)
    v_mfma_f32_32x32x16_bf16 v[144:159], v[212:215], v[56:59], v[144:159]
    ds_read_b64_tr_b16 v[212:213], v3 offset:13312
    ds_read_b64_tr_b16 v[214:215], v3 offset:13824
    s_waitcnt lgkmcnt(6)
    v_mfma_f32_32x32x16_bf16 v[160:175], v[216:219], v[60:63], v[160:175]
    buffer_load_dwordx4 v[104:107], v2, s[8:11], s67 offen offset:2048 sc1
    ds_read_b64_tr_b16 v[216:217], v3 offset:14336
    ds_read_b64_tr_b16 v[218:219], v3 offset:14848
    s_waitcnt lgkmcnt(6)
    v_mfma_f32_32x32x16_bf16 v[144:159], v[220:223], v[60:63], v[144:159]
    ds_read_b64_tr_b16 v[220:221], v3 offset:15360
    ds_read_b64_tr_b16 v[222:223], v3 offset:15872
    s_waitcnt lgkmcnt(6)
    v_mfma_f32_32x32x16_bf16 v[160:175], v[208:211], v[64:67], v[160:175]
    buffer_load_dwordx4 v[108:111], v2, s[8:11], s67 offen offset:3072 sc1
    ds_read_b64_tr_b16 v[208:209], v3 offset:16384
    ds_read_b64_tr_b16 v[210:211], v3 offset:16896
    s_waitcnt lgkmcnt(6)
    v_mfma_f32_32x32x16_bf16 v[144:159], v[212:215], v[64:67], v[144:159]
    buffer_load_dwordx4 v[112:115], v2, s[8:11], s68 offen offset:2048 sc1
    ds_read_b64_tr_b16 v[212:213], v3 offset:17408
    ds_read_b64_tr_b16 v[214:215], v3 offset:17920
    s_waitcnt lgkmcnt(6)
    v_mfma_f32_32x32x16_bf16 v[160:175], v[216:219], v[68:71], v[160:175]
    ds_read_b64_tr_b16 v[216:217], v3 offset:18432
    ds_read_b64_tr_b16 v[218:219], v3 offset:18944
    s_waitcnt lgkmcnt(6)
    v_mfma_f32_32x32x16_bf16 v[144:159], v[220:223], v[68:71], v[144:159]
    buffer_load_dwordx4 v[116:119], v2, s[8:11], s68 offen offset:3072 sc1
    ds_read_b64_tr_b16 v[220:221], v3 offset:19456
    ds_read_b64_tr_b16 v[222:223], v3 offset:19968
    s_waitcnt lgkmcnt(6)
    v_mfma_f32_32x32x16_bf16 v[160:175], v[208:211], v[72:75], v[160:175]
    ds_read_b64_tr_b16 v[208:209], v3 offset:20480
    ds_read_b64_tr_b16 v[210:211], v3 offset:20992
    s_waitcnt lgkmcnt(6)
    v_mfma_f32_32x32x16_bf16 v[144:159], v[212:215], v[72:75], v[144:159]
    buffer_load_dwordx4 v[120:123], v2, s[8:11], s69 offen offset:2048 sc1
    ds_read_b64_tr_b16 v[212:213], v3 offset:21504
    ds_read_b64_tr_b16 v[214:215], v3 offset:22016
    s_waitcnt lgkmcnt(6)
    v_mfma_f32_32x32x16_bf16 v[160:175], v[216:219], v[76:79], v[160:175]
    buffer_load_dwordx4 v[124:127], v2, s[8:11], s69 offen offset:3072 sc1
    ds_read_b64_tr_b16 v[216:217], v3 offset:22528
    ds_read_b64_tr_b16 v[218:219], v3 offset:23040
    s_waitcnt lgkmcnt(6)
    v_mfma_f32_32x32x16_bf16 v[144:159], v[220:223], v[76:79], v[144:159]
    ds_read_b64_tr_b16 v[220:221], v3 offset:23552
    ds_read_b64_tr_b16 v[222:223], v3 offset:24064
    s_waitcnt lgkmcnt(6)
    v_mfma_f32_32x32x16_bf16 v[160:175], v[208:211], v[80:83], v[160:175]
    buffer_load_dwordx4 v[128:131], v2, s[8:11], s70 offen offset:2048 sc1
    ds_read_b64_tr_b16 v[208:209], v3 offset:24576
    ds_read_b64_tr_b16 v[210:211], v3 offset:25088
    s_waitcnt lgkmcnt(6)
    v_mfma_f32_32x32x16_bf16 v[144:159], v[212:215], v[80:83], v[144:159]
    ds_read_b64_tr_b16 v[212:213], v3 offset:25600
    ds_read_b64_tr_b16 v[214:215], v3 offset:26112
    s_waitcnt lgkmcnt(6)
    v_mfma_f32_32x32x16_bf16 v[160:175], v[216:219], v[84:87], v[160:175]
    buffer_load_dwordx4 v[132:135], v2, s[8:11], s70 offen offset:3072 sc1
    ds_read_b64_tr_b16 v[216:217], v3 offset:26624
    ds_read_b64_tr_b16 v[218:219], v3 offset:27136
    s_waitcnt lgkmcnt(6)
    v_mfma_f32_32x32x16_bf16 v[144:159], v[220:223], v[84:87], v[144:159]
    buffer_load_dwordx4 v[136:139], v2, s[8:11], s71 offen offset:2048 sc1
    ds_read_b64_tr_b16 v[220:221], v3 offset:27648
    ds_read_b64_tr_b16 v[222:223], v3 offset:28160
    s_waitcnt lgkmcnt(6)
    v_mfma_f32_32x32x16_bf16 v[160:175], v[208:211], v[88:91], v[160:175]
    s_waitcnt lgkmcnt(4)
    v_mfma_f32_32x32x16_bf16 v[144:159], v[212:215], v[88:91], v[144:159]
    buffer_load_dwordx4 v[140:143], v2, s[8:11], s71 offen offset:3072 sc1
    s_waitcnt lgkmcnt(2)
    v_mfma_f32_32x32x16_bf16 v[160:175], v[216:219], v[92:95], v[160:175]
    s_waitcnt lgkmcnt(0)
    v_mfma_f32_32x32x16_bf16 v[144:159], v[220:223], v[92:95], v[144:159]
    v_mov_b32 v241, 132548
    s_mov_b64 exec, 1
    ds_add_u32 v241, v9
    s_mov_b64 exec, -1
    s_xor_b32 s55, s62, 1
    s_lshl_b32 s53, s55, 11
    s_add_u32 s53, s53, s48
    ds_read_b64_tr_b16 v[208:209], v3 offset:29696
    ds_read_b64_tr_b16 v[210:211], v3 offset:30208
    ds_read_b64_tr_b16 v[212:213], v3 offset:31744
    ds_read_b64_tr_b16 v[214:215], v3 offset:32256
    ds_read_b64_tr_b16 v[216:217], v3 offset:33792
    ds_read_b64_tr_b16 v[218:219], v3 offset:34304
    ds_read_b64_tr_b16 v[220:221], v3 offset:35840
    ds_read_b64_tr_b16 v[222:223], v3 offset:36352
    s_waitcnt lgkmcnt(6)
    v_mfma_f32_32x32x16_bf16 v[144:159], v[208:211], v[184:187], v[144:159]
    ds_read_b64_tr_b16 v[208:209], v3 offset:37888
    ds_read_b64_tr_b16 v[210:211], v3 offset:38400
    s_waitcnt lgkmcnt(6)
    v_mfma_f32_32x32x16_bf16 v[144:159], v[212:215], v[188:191], v[144:159]
    ds_read_b64_tr_b16 v[212:213], v3 offset:39936
    ds_read_b64_tr_b16 v[214:215], v3 offset:40448
    s_waitcnt vmcnt(11) lgkmcnt(6)
    v_mfma_f32_32x32x16_bf16 v[144:159], v[216:219], v[96:99], v[144:159]
    ds_read_b64_tr_b16 v[216:217], v3 offset:41984
    ds_read_b64_tr_b16 v[218:219], v3 offset:42496
    s_waitcnt vmcnt(10) lgkmcnt(6)
    v_mfma_f32_32x32x16_bf16 v[144:159], v[220:223], v[100:103], v[144:159]
    ds_read_b64_tr_b16 v[220:221], v3 offset:44032
    ds_read_b64_tr_b16 v[222:223], v3 offset:44544
    s_waitcnt vmcnt(9) lgkmcnt(6)
    v_mfma_f32_32x32x16_bf16 v[144:159], v[208:211], v[104:107], v[144:159]
    ds_read_b64_tr_b16 v[208:209], v3 offset:46080
    ds_read_b64_tr_b16 v[210:211], v3 offset:46592
    s_waitcnt vmcnt(8) lgkmcnt(6)
    v_mfma_f32_32x32x16_bf16 v[144:159], v[212:215], v[108:111], v[144:159]
    ds_read_b64_tr_b16 v[212:213], v3 offset:48128
    ds_read_b64_tr_b16 v[214:215], v3 offset:48640
    s_waitcnt vmcnt(7) lgkmcnt(6)
    v_mfma_f32_32x32x16_bf16 v[144:159], v[216:219], v[112:115], v[144:159]
    ds_read_b64_tr_b16 v[216:217], v3 offset:50176
    ds_read_b64_tr_b16 v[218:219], v3 offset:50688
    s_waitcnt vmcnt(6) lgkmcnt(6)
    v_mfma_f32_32x32x16_bf16 v[144:159], v[220:223], v[116:119], v[144:159]
    ds_read_b64_tr_b16 v[220:221], v3 offset:52224
    ds_read_b64_tr_b16 v[222:223], v3 offset:52736
    s_waitcnt vmcnt(5) lgkmcnt(6)
    v_mfma_f32_32x32x16_bf16 v[144:159], v[208:211], v[120:123], v[144:159]
    ds_read_b64_tr_b16 v[208:209], v3 offset:54272
    ds_read_b64_tr_b16 v[210:211], v3 offset:54784
    s_waitcnt vmcnt(4) lgkmcnt(6)
    v_mfma_f32_32x32x16_bf16 v[144:159], v[212:215], v[124:127], v[144:159]
    ds_read_b64_tr_b16 v[212:213], v3 offset:56320
    ds_read_b64_tr_b16 v[214:215], v3 offset:56832
    s_waitcnt vmcnt(3) lgkmcnt(6)
    v_mfma_f32_32x32x16_bf16 v[144:159], v[216:219], v[128:131], v[144:159]
    ds_read_b64_tr_b16 v[216:217], v3 offset:28672
    ds_read_b64_tr_b16 v[218:219], v3 offset:29184
    s_waitcnt vmcnt(2) lgkmcnt(6)
    v_mfma_f32_32x32x16_bf16 v[144:159], v[220:223], v[132:135], v[144:159]
    ds_read_b64_tr_b16 v[220:221], v3 offset:30720
    ds_read_b64_tr_b16 v[222:223], v3 offset:31232
    s_waitcnt vmcnt(1) lgkmcnt(6)
    v_mfma_f32_32x32x16_bf16 v[144:159], v[208:211], v[136:139], v[144:159]
    ds_read_b64_tr_b16 v[208:209], v3 offset:32768
    ds_read_b64_tr_b16 v[210:211], v3 offset:33280
    s_waitcnt vmcnt(0) lgkmcnt(6)
    v_mfma_f32_32x32x16_bf16 v[144:159], v[212:215], v[140:143], v[144:159]
    ds_read_b64_tr_b16 v[212:213], v3 offset:34816
    ds_read_b64_tr_b16 v[214:215], v3 offset:35328
    s_waitcnt lgkmcnt(6)
    v_mfma_f32_32x32x16_bf16 v[160:175], v[216:219], v[184:187], v[160:175]
    ds_read_b64_tr_b16 v[216:217], v3 offset:36864
    ds_read_b64_tr_b16 v[218:219], v3 offset:37376
    s_waitcnt lgkmcnt(6)
    v_mfma_f32_32x32x16_bf16 v[160:175], v[220:223], v[188:191], v[160:175]
    ds_read_b64_tr_b16 v[220:221], v3 offset:38912
    ds_read_b64_tr_b16 v[222:223], v3 offset:39424
    s_waitcnt lgkmcnt(6)
    v_mfma_f32_32x32x16_bf16 v[160:175], v[208:211], v[96:99], v[160:175]
    ds_read_b64_tr_b16 v[208:209], v3 offset:40960
    ds_read_b64_tr_b16 v[210:211], v3 offset:41472
    s_waitcnt lgkmcnt(6)
    v_mfma_f32_32x32x16_bf16 v[160:175], v[212:215], v[100:103], v[160:175]
    v_cvt_pk_bf16_f32 v246, v144, v145
    v_cvt_pk_bf16_f32 v247, v146, v147
    v_cvt_pk_bf16_f32 v248, v148, v149
    v_cvt_pk_bf16_f32 v249, v150, v151
    v_cvt_pk_bf16_f32 v250, v152, v153
    v_cvt_pk_bf16_f32 v251, v154, v155
    v_cvt_pk_bf16_f32 v252, v156, v157
    v_cvt_pk_bf16_f32 v253, v158, v159
    v_min_u32 v246, -2, v246
    v_min_u32 v247, -2, v247
    v_min_u32 v248, -2, v248
    v_min_u32 v249, -2, v249
    v_min_u32 v250, -2, v250
    v_min_u32 v251, -2, v251
    v_min_u32 v252, -2, v252
    v_min_u32 v253, -2, v253
    s_cmp_eq_u32 s61, 1
    s_cbranch_scc1 L_msl11
    buffer_store_dwordx4 v[246:249], v2, s[8:11], s53 offen sc1
    buffer_store_dwordx4 v[250:253], v2, s[8:11], s53 offen offset:1024 sc1
    s_branch L_mse11
L_msl11:
    buffer_store_dwordx4 v[246:249], v2, s[8:11], s53 offen
    buffer_store_dwordx4 v[250:253], v2, s[8:11], s53 offen offset:1024
L_mse11:
    ds_read_b64_tr_b16 v[212:213], v3 offset:43008
    ds_read_b64_tr_b16 v[214:215], v3 offset:43520
    s_waitcnt lgkmcnt(6)
    v_mfma_f32_32x32x16_bf16 v[160:175], v[216:219], v[104:107], v[160:175]
    ds_read_b64_tr_b16 v[216:217], v3 offset:45056
    ds_read_b64_tr_b16 v[218:219], v3 offset:45568
    s_waitcnt lgkmcnt(6)
    v_mfma_f32_32x32x16_bf16 v[160:175], v[220:223], v[108:111], v[160:175]
    ds_read_b64_tr_b16 v[220:221], v3 offset:47104
    ds_read_b64_tr_b16 v[222:223], v3 offset:47616
    s_waitcnt lgkmcnt(6)
    v_mfma_f32_32x32x16_bf16 v[160:175], v[208:211], v[112:115], v[160:175]
    ds_read_b64_tr_b16 v[208:209], v3 offset:49152
    ds_read_b64_tr_b16 v[210:211], v3 offset:49664
    s_waitcnt lgkmcnt(6)
    v_mfma_f32_32x32x16_bf16 v[160:175], v[212:215], v[116:119], v[160:175]
    ds_read_b64_tr_b16 v[212:213], v3 offset:51200
    ds_read_b64_tr_b16 v[214:215], v3 offset:51712
    s_waitcnt lgkmcnt(6)
    v_mfma_f32_32x32x16_bf16 v[160:175], v[216:219], v[120:123], v[160:175]
    ds_read_b64_tr_b16 v[216:217], v3 offset:53248
    ds_read_b64_tr_b16 v[218:219], v3 offset:53760
    s_waitcnt lgkmcnt(6)
    v_mfma_f32_32x32x16_bf16 v[160:175], v[220:223], v[124:127], v[160:175]
    ds_read_b64_tr_b16 v[220:221], v3 offset:55296
    ds_read_b64_tr_b16 v[222:223], v3 offset:55808
    s_waitcnt lgkmcnt(6)
    v_mfma_f32_32x32x16_bf16 v[160:175], v[208:211], v[128:131], v[160:175]
    s_waitcnt lgkmcnt(4)
    v_mfma_f32_32x32x16_bf16 v[160:175], v[212:215], v[132:135], v[160:175]
    s_waitcnt lgkmcnt(2)
    v_mfma_f32_32x32x16_bf16 v[160:175], v[216:219], v[136:139], v[160:175]
    s_waitcnt lgkmcnt(0)
    v_mfma_f32_32x32x16_bf16 v[160:175], v[220:223], v[140:143], v[160:175]
    s_nop 10
    s_mov_b32 s51, 0
L_xs:
    buffer_load_dwordx4 v[144:147], v2, s[8:11], s73 offen sc1
    buffer_load_dwordx4 v[148:151], v2, s[8:11], s73 offen offset:1024 sc1
    s_add_u32 s51, s51, 1
    s_cmp_gt_u32 s51, 0x40000
    s_cbranch_scc1 L_end
    s_waitcnt vmcnt(0)
    v_max3_u32 v152, v144, v145, v146
    v_max3_u32 v153, v147, v148, v149
    v_max3_u32 v152, v152, v150, v151
    v_max_u32 v152, v152, v153
    v_cmp_eq_u32 vcc, -1, v152
    s_nop 1
    s_cmp_lg_u64 vcc, 0
    s_cbranch_scc1 L_xs
    s_waitcnt vmcnt(0)
    v_mfma_f32_32x32x16_bf16 v[160:175], v[40:43], v[144:147], v[160:175]
    v_mfma_f32_32x32x16_bf16 v[160:175], v[44:47], v[148:151], v[160:175]
    s_nop 11
    v_cvt_pk_bf16_f32 v24, v160, v161
    v_cvt_pk_bf16_f32 v25, v162, v163
    v_cvt_pk_bf16_f32 v26, v164, v165
    v_cvt_pk_bf16_f32 v27, v166, v167
    v_cvt_pk_bf16_f32 v28, v168, v169
    v_cvt_pk_bf16_f32 v29, v170, v171
    v_cvt_pk_bf16_f32 v30, v172, v173
    v_cvt_pk_bf16_f32 v31, v174, v175
    s_cmp_eq_u32 s50, 1
    s_cbranch_scc1 L_final
    s_add_u32 s53, s73, 0
    s_cmp_eq_u32 s61, 1
    s_cbranch_scc1 L_msl12
    buffer_store_dwordx4 v[24:27], v2, s[8:11], s53 offen sc1
    buffer_store_dwordx4 v[28:31], v2, s[8:11], s53 offen offset:1024 sc1
    s_branch L_mse12
L_msl12:
    buffer_store_dwordx4 v[24:27], v2, s[8:11], s53 offen
    buffer_store_dwordx4 v[28:31], v2, s[8:11], s53 offen offset:1024
L_mse12:
    v_mov_b32 v192, 0
    v_mov_b32 v193, 0
    v_mov_b32 v194, 0
    v_mov_b32 v195, 0
    v_mov_b32 v196, 0x3f803f80
    v_dot2_f32_bf16 v192, v24, v196, v192
    v_dot2_f32_bf16 v193, v24, v24, v193
    v_dot2_f32_bf16 v194, v25, v196, v194
    v_dot2_f32_bf16 v195, v25, v25, v195
    v_dot2_f32_bf16 v192, v26, v196, v192
    v_dot2_f32_bf16 v193, v26, v26, v193
    v_dot2_f32_bf16 v194, v27, v196, v194
    v_dot2_f32_bf16 v195, v27, v27, v195
    v_dot2_f32_bf16 v192, v28, v196, v192
    v_dot2_f32_bf16 v193, v28, v28, v193
    v_dot2_f32_bf16 v194, v29, v196, v194
    v_dot2_f32_bf16 v195, v29, v29, v195
    v_dot2_f32_bf16 v192, v30, v196, v192
    v_dot2_f32_bf16 v193, v30, v30, v193
    v_dot2_f32_bf16 v194, v31, v196, v194
    v_dot2_f32_bf16 v195, v31, v31, v195
    s_lshl_b32 s54, s62, 8
    s_add_u32 s53, s48, s54
    s_add_u32 s53, s53, 28672
    v_lshlrev_b32 v197, 3, v1
    v_add_f32 v192, v192, v194
    v_add_f32 v193, v193, v195
    v_mov_b32 v195, v192
    s_nop 1
    v_permlane32_swap_b32 v192, v195
    v_add_f32 v192, v192, v195
    v_mov_b32 v196, v193
    s_nop 1
    v_permlane32_swap_b32 v193, v196
    v_add_f32 v193, v193, v196
    s_mov_b32 s58, -1
    s_mov_b32 s59, 0
    s_mov_b64 exec, s[58:59]
    s_cmp_eq_u32 s61, 1
    s_cbranch_scc1 L_msl13
    buffer_store_dwordx2 v[192:193], v197, s[8:11], s53 offen sc1
    s_branch L_mse13
L_msl13:
    buffer_store_dwordx2 v[192:193], v197, s[8:11], s53 offen
L_mse13:
    s_mov_b64 exec, -1
    s_lshl_b32 s54, s62, 2
    s_add_u32 s54, s54, s49
    s_add_u32 s54, s54, 180224
    s_waitcnt vmcnt(0)
    s_mov_b64 exec, 1
    s_cmp_eq_u32 s61, 1
    s_cbranch_scc1 L_msl14
    buffer_store_dword v9, v10, s[8:11], s54 offen offset:0 sc1
    s_branch L_mse14
L_msl14:
    buffer_store_dword v9, v10, s[8:11], s54 offen offset:0
L_mse14:
    s_mov_b64 exec, -1
L_cnext:
    s_cmp_eq_u32 s50, 1
    s_cbranch_scc1 L_end
    s_mov_b32 s50, 1
    s_add_u32 s49, s49, 180224
    s_add_u32 s65, s65, 4194304
    s_mov_b32 s63, 57344
    s_mov_b32 s64, 0
    s_branch L_cloop
L_final:
    v_permlane32_swap_b32 v24, v26
    v_permlane32_swap_b32 v25, v27
    v_permlane32_swap_b32 v28, v30
    v_permlane32_swap_b32 v29, v31
    v_and_b32 v160, 31, v1
    s_mov_b32 s52, 896
    v_mul_lo_u32 v160, v160, s52
    v_lshrrev_b32 v161, 5, v1
    v_lshl_add_u32 v160, v161, 4, v160
    s_mul_i32 s53, s47, 28672
    s_lshl_b32 s54, s62, 6
    s_add_u32 s53, s53, s54
    buffer_store_dwordx4 v[24:27], v160, s[24:27], s53 offen
    buffer_store_dwordx4 v[28:31], v160, s[24:27], s53 offen offset:32
    s_endpgm
L_helper:
    v_lshrrev_b32 v216, 2, v1
    v_and_b32 v217, 3, v1
    s_mov_b32 s52, 2688
    v_mul_lo_u32 v3, v216, s52
    v_lshl_add_u32 v3, v217, 4, v3
    s_mov_b32 s52, 3584
    v_mul_lo_u32 v4, v216, s52
    v_lshl_add_u32 v4, v217, 4, v4
    s_mov_b32 s52, 896
    v_mul_lo_u32 v5, v216, s52
    v_lshl_add_u32 v5, v217, 4, v5
    s_mul_i32 s53, s45, 56
    s_andn2_b32 s53, s53, 15
    s_lshr_b32 s52, s46, 1
    s_mul_i32 s66, s52, 43008
    s_and_b32 s54, s46, 1
    s_mul_i32 s54, s54, 896
    s_add_u32 s66, s66, s54
    s_add_u32 s66, s66, s53
    s_add_u32 s66, s66, 896
    s_mul_i32 s67, s46, 43008
    s_add_u32 s67, s67, s53
    s_mul_i32 s68, s46, 57344
    s_lshl_b32 s54, s45, 8
    s_add_u32 s68, s68, s54
    s_mov_b32 s69, s60
    s_add_u32 s70, s60, 57344
    s_add_u32 m0, s69, 0
    s_add_u32 s52, s66, 0
    buffer_load_dwordx4 v3, s[4:7], s52 offen lds
    s_add_u32 m0, s69, 4096
    s_add_u32 s52, s66, 86016
    buffer_load_dwordx4 v3, s[4:7], s52 offen lds
    s_add_u32 m0, s69, 8192
    s_add_u32 s52, s66, 172032
    buffer_load_dwordx4 v3, s[4:7], s52 offen lds
    s_add_u32 m0, s69, 12288
    s_add_u32 s52, s66, 258048
    buffer_load_dwordx4 v3, s[4:7], s52 offen lds
    s_add_u32 m0, s69, 16384
    s_add_u32 s52, s66, 344064
    buffer_load_dwordx4 v3, s[4:7], s52 offen lds
    s_add_u32 m0, s69, 20480
    s_add_u32 s52, s66, 430080
    buffer_load_dwordx4 v3, s[4:7], s52 offen lds
    s_add_u32 m0, s69, 24576
    s_add_u32 s52, s66, 516096
    buffer_load_dwordx4 v3, s[4:7], s52 offen lds
    s_add_u32 m0, s69, 28672
    s_add_u32 s52, s66, 602112
    buffer_load_dwordx4 v3, s[4:7], s52 offen lds
    s_add_u32 m0, s69, 32768
    s_add_u32 s52, s66, 688128
    buffer_load_dwordx4 v3, s[4:7], s52 offen lds
    s_add_u32 m0, s69, 36864
    s_add_u32 s52, s66, 774144
    buffer_load_dwordx4 v3, s[4:7], s52 offen lds
    s_add_u32 m0, s69, 40960
    s_add_u32 s52, s66, 860160
    buffer_load_dwordx4 v3, s[4:7], s52 offen lds
    s_add_u32 m0, s69, 45056
    s_add_u32 s52, s66, 946176
    buffer_load_dwordx4 v3, s[4:7], s52 offen lds
    s_add_u32 m0, s69, 49152
    s_add_u32 s52, s66, 1032192
    buffer_load_dwordx4 v3, s[4:7], s52 offen lds
    s_add_u32 m0, s69, 53248
    s_add_u32 s52, s66, 1118208
    buffer_load_dwordx4 v3, s[4:7], s52 offen lds
    s_cmp_ge_u32 s45, 14
    s_cselect_b32 s18, 0, s18
    s_cselect_b32 s14, 0, s14
    s_cselect_b32 s22, 0, s22
    v_lshrrev_b32 v224, 5, v1
    v_lshlrev_b32 v224, 8, v224
    v_bfe_u32 v225, v1, 2, 2
    v_lshl_add_u32 v224, v225, 6, v224
    v_bfe_u32 v225, v1, 4, 1
    v_lshl_add_u32 v224, v225, 5, v224
    v_and_b32 v225, 3, v1
    v_lshl_add_u32 v16, v225, 3, v224
    s_lshl_b32 s52, s46, 11
    s_add_u32 s52, s52, 114688
    v_add_u32 v14, s52, v2
    s_lshl_b32 s71, s45, 13
    s_add_u32 s71, s71, s48
    s_add_u32 s71, s71, 94208
    s_lshl_b32 s55, s44, 4
    s_add_u32 s52, s55, s45
    s_lshl_b32 s72, s52, 7
    s_add_u32 s72, s72, 22118400
    s_mov_b32 s93, s52
    s_and_b32 s53, s46, 1
    s_lshl_b32 s53, s53, 9
    s_lshl_b32 s54, s46, 7
    s_add_u32 s55, s53, s54
    s_xor_b32 s53, s55, 512
    v_lshlrev_b32 v216, 2, v1
    v_add_u32 v216, s53, v216
    v_add_u32 v216, 155648, v216
    s_mov_b64 exec, 0xffffffff
    ds_write_b32 v216, v10
    s_mov_b64 exec, -1
    s_waitcnt vmcnt(0)
    s_waitcnt vmcnt(0) lgkmcnt(0)
    s_add_u32 s90, s60, 0
    s_mov_b32 s91, 14
    s_add_u32 s92, s55, 155648
    s_call_b64 s[88:89], L_sub_ps
    s_cmp_lg_u32 s46, 3
    s_cbranch_scc1 L_hs1
    v_mov_b32 v222, 132548
    s_mov_b32 s51, 0
L_hw0:
    ds_read_b32 v220, v222
    s_add_u32 s51, s51, 1
    s_cmp_gt_u32 s51, 0x1000000
    s_cbranch_scc1 L_end
    s_waitcnt lgkmcnt(0)
    v_readfirstlane_b32 s56, v220
    s_nop 3
    s_cmp_lt_u32 s56, 4
    s_cbranch_scc1 L_hw0
    s_getreg_b32 s73, hwreg(HW_REG_XCC_ID)
    s_and_b32 s73, s73, 15
    s_add_u32 s73, s73, 1
    v_mov_b32 v220, s73
    s_mov_b64 exec, 1
    buffer_store_byte v220, v10, s[40:43], s93 offen sc1
    s_mov_b64 exec, -1
L_hs1:
    s_nop 1
    s_branch L_hba
L_hloop:
    s_add_u32 s69, s60, s63
    s_add_u32 s70, s60, s64
L_hba:
    s_barrier
    s_cmp_eq_u32 s50, 1
    s_cbranch_scc1 L_hl1a
    s_cmp_ge_u32 s46, 2
    s_cbranch_scc1 L_hl0a
    s_lshl_b32 s53, s46, 9
    s_lshl_b32 s54, s46, 8
    s_add_u32 s90, s53, 155648
    s_add_u32 s92, s54, 131072
    s_call_b64 s[88:89], L_sub_cv
L_hl0a:
    s_barrier
    s_add_u32 m0, s70, 0
    s_add_u32 s52, s67, 0
    buffer_load_dwordx4 v3, s[4:7], s52 offen lds
    s_add_u32 m0, s70, 4096
    s_add_u32 s52, s67, 172032
    buffer_load_dwordx4 v3, s[4:7], s52 offen lds
    s_add_u32 m0, s70, 8192
    s_add_u32 s52, s67, 344064
    buffer_load_dwordx4 v3, s[4:7], s52 offen lds
    s_add_u32 m0, s70, 12288
    s_add_u32 s52, s67, 516096
    buffer_load_dwordx4 v3, s[4:7], s52 offen lds
    s_add_u32 m0, s70, 16384
    s_add_u32 s52, s67, 688128
    buffer_load_dwordx4 v3, s[4:7], s52 offen lds
    s_add_u32 m0, s70, 20480
    s_add_u32 s52, s67, 860160
    buffer_load_dwordx4 v3, s[4:7], s52 offen lds
    s_add_u32 m0, s70, 24576
    s_add_u32 s52, s67, 1032192
    buffer_load_dwordx4 v3, s[4:7], s52 offen lds
    s_and_b32 s53, s44, 1
    s_lshl_b32 s53, s53, 2
    s_add_u32 s53, s53, s46
    s_mul_i32 s53, s53, 200704
    s_lshl_b32 s54, s45, 8
    s_add_u32 s53, s53, s54
    s_mov_b32 s52, 3584
    v_mul_lo_u32 v17, v1, s52
    s_mov_b32 s58, -1
    s_mov_b32 s59, 0xffffff
    s_mov_b64 exec, s[58:59]
    buffer_load_dword v18, v17, s[16:19], s53 offen sc1
    s_mov_b64 exec, -1
    v_add_u32 v216, s60, v2
    ds_read_b128 v[132:135], v216 offset:0
    ds_read_b128 v[136:139], v216 offset:4096
    ds_read_b128 v[140:143], v216 offset:8192
    ds_read_b128 v[144:147], v216 offset:12288
    ds_read_b128 v[148:151], v216 offset:16384
    ds_read_b128 v[152:155], v216 offset:20480
    ds_read_b128 v[156:159], v216 offset:24576
    ds_read_b128 v[160:163], v216 offset:28672
    ds_read_b128 v[164:167], v216 offset:32768
    ds_read_b128 v[168:171], v216 offset:36864
    ds_read_b128 v[172:175], v216 offset:40960
    ds_read_b128 v[176:179], v216 offset:45056
    ds_read_b128 v[180:183], v216 offset:49152
    ds_read_b128 v[184:187], v216 offset:53248
    s_waitcnt lgkmcnt(0)
    s_cmp_lg_u32 s46, 3
    s_cbranch_scc1 L_hnl
    s_cmp_lg_u32 s45, 0
    s_cbranch_scc1 L_hnl
    s_lshl_b32 s55, s44, 4
    v_lshlrev_b32 v223, 2, v1
    v_add_u32 v223, s55, v223
    v_subrev_u32 v223, 32, v223
    v_max_i32 v223, 0, v223
    s_mov_b32 s52, 0x80808080
    s_mov_b64 exec, 0xfff
    s_nop 1
    s_mov_b32 s51, 0
L_lead:
    buffer_load_dword v221, v223, s[40:43], 0 offen sc1
    s_add_u32 s51, s51, 1
    s_cmp_gt_u32 s51, 0x40000
    s_cbranch_scc1 L_end
    s_waitcnt vmcnt(0)
    v_subrev_u32 v224, 0x01010101, v221
    v_and_b32 v224, s52, v224
    v_cmp_ne_u32 vcc, 0, v224
    s_nop 1
    s_and_b32 s57, vcc_lo, 0xfff
    s_cbranch_scc1 L_lead
    s_mul_i32 s52, s73, 0x01010101
    v_cmp_ne_u32 vcc, s52, v221
    s_nop 2
    s_and_b32 s56, vcc_lo, 0xf00
    s_cselect_b32 s56, 1, 2
    s_mov_b64 exec, -1
    v_mov_b32 v220, s56
    s_mov_b64 exec, 0xffff
    v_lshlrev_b32 v221, 7, v1
    buffer_store_dword v220, v221, s[8:11], s72 offen sc1
    s_mov_b64 exec, -1
L_hnl:
    s_nop 1
    s_lshl_b32 s54, s46, 7
    s_waitcnt vmcnt(1)
    s_add_u32 s90, s60, 57344
    s_mov_b32 s91, 7
    s_add_u32 s92, s54, 156672
    s_call_b64 s[88:89], L_sub_ps
    v_add_u32 v216, s60, v2
    v_add_u32 v216, 57344, v216
    ds_read_b128 v[188:191], v216 offset:0
    ds_read_b128 v[192:195], v216 offset:4096
    ds_read_b128 v[196:199], v216 offset:8192
    ds_read_b128 v[200:203], v216 offset:12288
    ds_read_b128 v[204:207], v216 offset:16384
    ds_read_b128 v[208:211], v216 offset:20480
    ds_read_b128 v[212:215], v216 offset:24576
    s_waitcnt lgkmcnt(0)
    s_branch L_hb1
L_hl1a:
    s_waitcnt vmcnt(0)
L_hb1:
    s_barrier
    s_cmp_eq_u32 s50, 1
    s_cbranch_scc1 L_hgo
    s_cmp_lg_u32 s46, 2
    s_cbranch_scc1 L_hq1
    s_mov_b32 s90, 156672
    s_mov_b32 s92, 132096
    s_call_b64 s[88:89], L_sub_cv
L_hq1:
    s_barrier
    s_cmp_lg_u32 s46, 3
    s_cbranch_scc1 L_hgw
    v_mov_b32 v221, 132544
    s_mov_b64 exec, 1
    s_mov_b32 s51, 0
L_poll8:
    v_mov_b32 v220, 0
    buffer_atomic_add v220, v10, s[8:11], s72 offen sc0 sc1
    s_add_u32 s51, s51, 1
    s_cmp_gt_u32 s51, 0x40000
    s_cbranch_scc1 L_end
    s_waitcnt vmcnt(0)
    v_cmp_eq_u32 vcc, 0, v220
    s_nop 1
    s_and_b32 s57, vcc_lo, 1
    s_cbranch_scc1 L_poll8
    ds_write_b32 v221, v220
    s_mov_b64 exec, -1
L_hgw:
    v_mov_b32 v221, 132544
    s_mov_b32 s51, 0
L_hgm:
    ds_read_b32 v220, v221
    s_add_u32 s51, s51, 1
    s_cmp_gt_u32 s51, 0x1000000
    s_cbranch_scc1 L_end
    s_waitcnt lgkmcnt(0)
    v_readfirstlane_b32 s61, v220
    s_nop 3
    s_cmp_eq_u32 s61, 0
    s_cbranch_scc1 L_hgm
    s_sub_u32 s61, s61, 1
L_hgo:
    s_nop 1
    s_lshl_b32 s52, s46, 12
    s_add_u32 s56, s52, s63
    v_add_u32 v15, s56, v2
    v_mov_b32 v216, 0
    v_mov_b32 v217, 0
    v_mov_b32 v218, 0
    v_mov_b32 v219, 0
    v_mov_b32 v220, 0
    v_mov_b32 v221, 0
    v_mov_b32 v222, 0
    v_mov_b32 v223, 0
    s_mov_b32 s58, 0
    s_mov_b32 s59, -1
    s_mov_b64 exec, s[58:59]
    v_mov_b32 v222, 0xf149
    s_mov_b64 exec, -1
    s_cmp_ge_u32 s47, 8
    s_cbranch_scc1 L_h2
    ds_write_b128 v15, v[216:219] offset:0
    ds_write_b128 v15, v[220:223] offset:1024
    ds_write_b128 v15, v[216:219] offset:2048
    ds_write_b128 v15, v[216:219] offset:3072
    s_cmp_ge_u32 s47, 4
    s_cbranch_scc1 L_h2
    ds_write_b128 v15, v[216:219] offset:16384
    ds_write_b128 v15, v[220:223] offset:17408
    ds_write_b128 v15, v[216:219] offset:18432
    ds_write_b128 v15, v[216:219] offset:19456
    s_branch L_h0
L_h2:
    s_cmp_lt_u32 s47, 8
    s_cselect_b32 s55, 2, 3
    s_mul_i32 s53, s45, 72
    s_add_u32 s53, s53, s47
    s_lshl_b32 s53, s53, 7
    s_lshl_b32 s54, s47, 9
    s_sub_u32 s54, s49, s54
    s_add_u32 s54, s54, s53
    s_add_u32 s54, s54, 32768
    v_lshlrev_b32 v226, 2, v1
    s_mov_b64 exec, 3
    s_waitcnt vmcnt(0) lgkmcnt(0)
    s_nop 1
    s_mov_b32 s51, 0
L_poll9:
    v_mov_b32 v225, 0
    buffer_atomic_add v225, v226, s[8:11], s54 offen sc0 sc1
    s_add_u32 s51, s51, 1
    s_cmp_gt_u32 s51, 0x40000
    s_cbranch_scc1 L_end
    s_waitcnt vmcnt(0)
    v_cmp_eq_u32 vcc, 0, v225
    s_nop 1
    s_and_b32 s57, vcc_lo, s55
    s_cbranch_scc1 L_poll9
    s_mov_b64 exec, -1
    s_sub_u32 s54, s65, 16384
    s_add_u32 m0, s56, 16384
    s_nop 0
    buffer_load_dwordx4 v2, s[8:11], s54 offen offset:0 sc1 lds
    buffer_load_dwordx4 v2, s[8:11], s54 offen offset:1024 sc1 lds
    buffer_load_dwordx4 v2, s[8:11], s54 offen offset:2048 sc1 lds
    buffer_load_dwordx4 v2, s[8:11], s54 offen offset:3072 sc1 lds
    s_cmp_lt_u32 s47, 8
    s_cbranch_scc1 L_h0
    s_sub_u32 s54, s54, 16384
    s_mov_b32 m0, s56
    s_nop 0
    buffer_load_dwordx4 v2, s[8:11], s54 offen offset:0 sc1 lds
    buffer_load_dwordx4 v2, s[8:11], s54 offen offset:1024 sc1 lds
    buffer_load_dwordx4 v2, s[8:11], s54 offen offset:2048 sc1 lds
    buffer_load_dwordx4 v2, s[8:11], s54 offen offset:3072 sc1 lds
L_h0:
    s_waitcnt lgkmcnt(0)
    s_waitcnt vmcnt(0) lgkmcnt(0)
    s_barrier
    s_cmp_eq_u32 s50, 1
    s_cbranch_scc1 L_ha1
    v_lshlrev_b32 v17, 7, v1
    s_mul_i32 s53, s45, 3840
    s_add_u32 s53, s53, s48
    s_add_u32 s53, s53, 32768
    s_mov_b64 exec, 0x3fffffff
    buffer_load_dword v0, v17, s[8:11], s53 offen sc1
    s_mov_b64 exec, -1
    s_mul_i32 s54, s46, 14336
    s_lshl_b32 s55, s62, 6
    s_add_u32 s54, s54, s55
    s_add_u32 m0, s60, 135168
    s_add_u32 s52, s54, 0
    buffer_load_dwordx4 v5, s[12:15], s52 offen lds
    s_add_u32 m0, s60, 139264
    s_add_u32 s52, s54, 57344
    buffer_load_dwordx4 v5, s[12:15], s52 offen lds
    s_add_u32 m0, s60, 143360
    s_add_u32 s52, s54, 114688
    buffer_load_dwordx4 v5, s[12:15], s52 offen lds
    s_add_u32 m0, s60, 147456
    s_add_u32 s52, s54, 172032
    buffer_load_dwordx4 v5, s[12:15], s52 offen lds
    s_add_u32 m0, s60, 151552
    s_add_u32 s52, s54, 229376
    buffer_load_dwordx4 v5, s[12:15], s52 offen lds
    s_add_u32 m0, s60, 155648
    s_add_u32 s52, s54, 286720
    buffer_load_dwordx4 v5, s[12:15], s52 offen lds
    s_add_u32 m0, s60, 159744
    s_add_u32 s52, s54, 344064
    buffer_load_dwordx4 v5, s[12:15], s52 offen lds
L_ha1:
    s_and_b32 s53, s44, 1
    s_lshl_b32 s53, s53, 2
    s_add_u32 s53, s53, s46
    s_mul_i32 s53, s53, 200704
    s_lshl_b32 s54, s45, 8
    s_add_u32 s53, s53, s54
    s_add_u32 s53, s53, 128
    s_mov_b32 s52, 3584
    v_mul_lo_u32 v17, v1, s52
    s_mov_b32 s58, -1
    s_mov_b32 s59, 0xffffff
    s_mov_b64 exec, s[58:59]
    buffer_load_dword v18, v17, s[16:19], s53 offen sc1
    s_mov_b64 exec, -1
    s_add_u32 m0, s70, 28672
    s_add_u32 s52, s68, 0
    buffer_load_dwordx4 v4, s[16:19], s52 offen lds
    s_add_u32 m0, s70, 0
    s_add_u32 s52, s68, 64
    buffer_load_dwordx4 v4, s[16:19], s52 offen lds
    s_add_u32 m0, s70, 32768
    s_add_u32 s52, s68, 229376
    buffer_load_dwordx4 v4, s[16:19], s52 offen lds
    s_add_u32 m0, s70, 4096
    s_add_u32 s52, s68, 229440
    buffer_load_dwordx4 v4, s[16:19], s52 offen lds
    s_add_u32 m0, s70, 36864
    s_add_u32 s52, s68, 458752
    buffer_load_dwordx4 v4, s[16:19], s52 offen lds
    s_add_u32 m0, s70, 8192
    s_add_u32 s52, s68, 458816
    buffer_load_dwordx4 v4, s[16:19], s52 offen lds
    s_add_u32 m0, s70, 40960
    s_add_u32 s52, s68, 688128
    buffer_load_dwordx4 v4, s[16:19], s52 offen lds
    s_add_u32 m0, s70, 12288
    s_add_u32 s52, s68, 688192
    buffer_load_dwordx4 v4, s[16:19], s52 offen lds
    s_add_u32 m0, s70, 45056
    s_add_u32 s52, s68, 917504
    buffer_load_dwordx4 v4, s[16:19], s52 offen lds
    s_add_u32 m0, s70, 16384
    s_add_u32 s52, s68, 917568
    buffer_load_dwordx4 v4, s[16:19], s52 offen lds
    s_add_u32 m0, s70, 49152
    s_add_u32 s52, s68, 1146880
    buffer_load_dwordx4 v4, s[16:19], s52 offen lds
    s_add_u32 m0, s70, 20480
    s_add_u32 s52, s68, 1146944
    buffer_load_dwordx4 v4, s[16:19], s52 offen lds
    s_add_u32 m0, s70, 53248
    s_add_u32 s52, s68, 1376256
    buffer_load_dwordx4 v4, s[16:19], s52 offen lds
    s_add_u32 m0, s70, 24576
    s_add_u32 s52, s68, 1376320
    buffer_load_dwordx4 v4, s[16:19], s52 offen lds
    s_waitcnt vmcnt(0)
    s_waitcnt vmcnt(0)
    s_barrier
    v_add_u32 v252, s69, v2
    v_add_u32 v253, s70, v2
    s_cmp_lt_u32 s45, 14
    s_cbranch_scc1 L_hp3
    s_cmp_eq_u32 s50, 1
    s_cbranch_scc1 L_hnext
    ds_write_b128 v253, v[132:135] offset:0
    ds_write_b128 v253, v[136:139] offset:4096
    ds_write_b128 v253, v[140:143] offset:8192
    ds_write_b128 v253, v[144:147] offset:12288
    ds_write_b128 v253, v[148:151] offset:16384
    ds_write_b128 v253, v[152:155] offset:20480
    ds_write_b128 v253, v[156:159] offset:24576
    ds_write_b128 v253, v[160:163] offset:28672
    ds_write_b128 v253, v[164:167] offset:32768
    ds_write_b128 v253, v[168:171] offset:36864
    ds_write_b128 v253, v[172:175] offset:40960
    ds_write_b128 v253, v[176:179] offset:45056
    ds_write_b128 v253, v[180:183] offset:49152
    ds_write_b128 v253, v[184:187] offset:53248
    ds_write_b128 v252, v[188:191] offset:0
    ds_write_b128 v252, v[192:195] offset:4096
    ds_write_b128 v252, v[196:199] offset:8192
    ds_write_b128 v252, v[200:203] offset:12288
    ds_write_b128 v252, v[204:207] offset:16384
    ds_write_b128 v252, v[208:211] offset:20480
    ds_write_b128 v252, v[212:215] offset:24576
    v_lshlrev_b32 v218, 7, v1
    s_and_b32 s55, s44, 1
    s_lshl_b32 s55, s55, 1
    s_add_u32 s55, s55, s45
    s_sub_u32 s55, s55, 14
    s_lshl_b32 s55, s55, 2
    s_add_u32 s55, s55, s46
    s_mul_i32 s55, s55, 100352
    s_mov_b32 s18, 0x188000
    s_mov_b32 s22, 0x188000
    s_mov_b32 s53, s55
    buffer_load_dword v20, v218, s[20:23], s53 offen sc1
    s_add_u32 s53, s53, 8192
    buffer_load_dword v21, v218, s[20:23], s53 offen sc1
    s_add_u32 s53, s53, 8192
    buffer_load_dword v22, v218, s[20:23], s53 offen sc1
    s_add_u32 s53, s53, 8192
    buffer_load_dword v23, v218, s[20:23], s53 offen sc1
    s_add_u32 s53, s53, 8192
    buffer_load_dword v24, v218, s[20:23], s53 offen sc1
    s_add_u32 s53, s53, 8192
    buffer_load_dword v25, v218, s[20:23], s53 offen sc1
    s_add_u32 s53, s53, 8192
    buffer_load_dword v26, v218, s[20:23], s53 offen sc1
    s_add_u32 s53, s53, 8192
    buffer_load_dword v27, v218, s[20:23], s53 offen sc1
    s_add_u32 s53, s53, 8192
    buffer_load_dword v28, v218, s[20:23], s53 offen sc1
    s_add_u32 s53, s53, 8192
    buffer_load_dword v29, v218, s[20:23], s53 offen sc1
    s_add_u32 s53, s53, 8192
    buffer_load_dword v30, v218, s[20:23], s53 offen sc1
    s_add_u32 s53, s53, 8192
    buffer_load_dword v31, v218, s[20:23], s53 offen sc1
    s_add_u32 s53, s53, 8192
    buffer_load_dword v32, v218, s[20:23], s53 offen sc1
    s_add_u32 s53, s53, 8192
    s_sub_u32 s53, s45, 14
    s_mul_i32 s53, s53, 57344
    s_add_u32 s53, s53, s48
    s_add_u32 s53, s53, 94208
    s_sub_u32 s53, s45, 14
    s_lshl_b32 s53, s53, 14
    s_add_u32 s53, s53, s48
    buffer_load_dword v246, v218, s[8:11], s53 offen sc1
    s_add_u32 s53, s53, 8192
    buffer_load_dword v247, v218, s[8:11], s53 offen sc1
    s_add_u32 s53, s53, 8192
    s_waitcnt vmcnt(0) lgkmcnt(0)
    s_mov_b32 s51, 0
L_poll10:
    buffer_load_dword v216, v7, s[8:11], s49 offen offset:384 sc1
    s_add_u32 s51, s51, 1
    s_cmp_gt_u32 s51, 0x40000
    s_cbranch_scc1 L_end
    s_waitcnt vmcnt(0)
    v_cmp_eq_u32 vcc, 0, v216
    s_nop 1
    s_and_b32 s57, vcc_lo, 0x3fff
    s_cbranch_scc1 L_poll10
    buffer_load_dword v36, v218, s[16:19], s55 offen sc1
    s_add_u32 s55, s55, 8192
    buffer_load_dword v37, v218, s[16:19], s55 offen sc1
    s_add_u32 s55, s55, 8192
    buffer_load_dword v38, v218, s[16:19], s55 offen sc1
    s_add_u32 s55, s55, 8192
    buffer_load_dword v39, v218, s[16:19], s55 offen sc1
    s_add_u32 s55, s55, 8192
    buffer_load_dword v40, v218, s[16:19], s55 offen sc1
    s_add_u32 s55, s55, 8192
    buffer_load_dword v41, v218, s[16:19], s55 offen sc1
    s_add_u32 s55, s55, 8192
    buffer_load_dword v42, v218, s[16:19], s55 offen sc1
    s_add_u32 s55, s55, 8192
    buffer_load_dword v43, v218, s[16:19], s55 offen sc1
    s_add_u32 s55, s55, 8192
    buffer_load_dword v44, v218, s[16:19], s55 offen sc1
    s_add_u32 s55, s55, 8192
    buffer_load_dword v45, v218, s[16:19], s55 offen sc1
    s_add_u32 s55, s55, 8192
    buffer_load_dword v46, v218, s[16:19], s55 offen sc1
    s_add_u32 s55, s55, 8192
    buffer_load_dword v47, v218, s[16:19], s55 offen sc1
    s_add_u32 s55, s55, 8192
    buffer_load_dword v48, v218, s[16:19], s55 offen sc1
    s_add_u32 s55, s55, 8192
    s_mov_b32 s18, 0
    s_waitcnt vmcnt(0)
    s_branch L_hnext
L_hp3:
    s_waitcnt vmcnt(0)
    s_add_u32 m0, s69, 0
    s_add_u32 s52, s68, 128
    buffer_load_dwordx4 v4, s[16:19], s52 offen lds
    s_add_u32 m0, s69, 28672
    s_add_u32 s52, s68, 192
    buffer_load_dwordx4 v4, s[16:19], s52 offen lds
    s_add_u32 m0, s69, 4096
    s_add_u32 s52, s68, 229504
    buffer_load_dwordx4 v4, s[16:19], s52 offen lds
    s_add_u32 m0, s69, 32768
    s_add_u32 s52, s68, 229568
    buffer_load_dwordx4 v4, s[16:19], s52 offen lds
    s_add_u32 m0, s69, 8192
    s_add_u32 s52, s68, 458880
    buffer_load_dwordx4 v4, s[16:19], s52 offen lds
    s_add_u32 m0, s69, 36864
    s_add_u32 s52, s68, 458944
    buffer_load_dwordx4 v4, s[16:19], s52 offen lds
    s_add_u32 m0, s69, 12288
    s_add_u32 s52, s68, 688256
    buffer_load_dwordx4 v4, s[16:19], s52 offen lds
    s_add_u32 m0, s69, 40960
    s_add_u32 s52, s68, 688320
    buffer_load_dwordx4 v4, s[16:19], s52 offen lds
    s_add_u32 m0, s69, 16384
    s_add_u32 s52, s68, 917632
    buffer_load_dwordx4 v4, s[16:19], s52 offen lds
    s_add_u32 m0, s69, 45056
    s_add_u32 s52, s68, 917696
    buffer_load_dwordx4 v4, s[16:19], s52 offen lds
    s_add_u32 m0, s69, 20480
    s_add_u32 s52, s68, 1147008
    buffer_load_dwordx4 v4, s[16:19], s52 offen lds
    s_add_u32 m0, s69, 49152
    s_add_u32 s52, s68, 1147072
    buffer_load_dwordx4 v4, s[16:19], s52 offen lds
    s_add_u32 m0, s69, 24576
    s_add_u32 s52, s68, 1376384
    buffer_load_dwordx4 v4, s[16:19], s52 offen lds
    s_add_u32 m0, s69, 53248
    s_add_u32 s52, s68, 1376448
    buffer_load_dwordx4 v4, s[16:19], s52 offen lds
    s_cmp_eq_u32 s50, 1
    s_cbranch_scc1 L_hnc1
    s_lshl_b32 s54, s46, 7
    s_add_u32 s90, s60, 86016
    s_mov_b32 s91, 7
    s_add_u32 s92, s54, 114688
    s_call_b64 s[88:89], L_sub_ps
    s_add_u32 s90, s60, 57344
    s_mov_b32 s91, 7
    s_add_u32 s92, s54, 115200
    s_call_b64 s[88:89], L_sub_ps
    s_waitcnt vmcnt(0)
    s_add_u32 s90, s60, 0
    s_mov_b32 s91, 7
    s_add_u32 s92, s54, 115712
    s_call_b64 s[88:89], L_sub_ps
    s_add_u32 s90, s60, 28672
    s_mov_b32 s91, 7
    s_add_u32 s92, s54, 116224
    s_call_b64 s[88:89], L_sub_ps
L_hnc1:
    s_waitcnt vmcnt(0) lgkmcnt(0)
    s_waitcnt vmcnt(0)
    s_barrier
    s_cmp_eq_u32 s50, 1
    s_cbranch_scc1 L_hnc2
    v_and_b32 v17, 15, v1
    v_lshlrev_b32 v17, 2, v17
    s_lshl_b32 s56, s45, 8
    s_lshl_b32 s52, s46, 6
    s_add_u32 s56, s56, s52
    buffer_load_dword v18, v17, s[36:39], s56 offen
    s_lshl_b32 s53, s46, 9
    s_and_b32 s54, s46, 1
    s_lshl_b32 s54, s54, 8
    s_lshr_b32 s55, s46, 1
    s_lshl_b32 s55, s55, 10
    s_add_u32 s54, s54, s55
    s_add_u32 s90, s53, 114688
    s_add_u32 s92, s54, 133120
    s_call_b64 s[88:89], L_sub_cv
    v_lshlrev_b32 v17, 2, v1
    v_add_u32 v17, s92, v17
    s_mov_b32 s58, -1
    s_mov_b32 s59, 0xffff
    s_mov_b64 exec, s[58:59]
    s_waitcnt vmcnt(0)
    ds_write_b32 v17, v18 offset:512
    s_mov_b64 exec, -1
    s_waitcnt lgkmcnt(0)
    s_barrier
L_hnc2:
    s_mov_b32 s51, 0
L_poll11:
    buffer_load_dword v216, v7, s[8:11], s49 offen offset:128 sc1
    s_add_u32 s51, s51, 1
    s_cmp_gt_u32 s51, 0x40000
    s_cbranch_scc1 L_end
    s_waitcnt vmcnt(0)
    v_cmp_eq_u32 vcc, 0, v216
    s_nop 1
    s_and_b32 s57, vcc_lo, 0x3fff
    s_cbranch_scc1 L_poll11
    s_add_u32 s53, s48, 90112
    buffer_load_dwordx2 v[216:217], v6, s[8:11], s53 offen offset:0 sc1
    buffer_load_dwordx2 v[218:219], v6, s[8:11], s53 offen offset:256 sc1
    buffer_load_dwordx2 v[220:221], v6, s[8:11], s53 offen offset:512 sc1
    buffer_load_dwordx2 v[222:223], v6, s[8:11], s53 offen offset:768 sc1
    buffer_load_dwordx2 v[224:225], v6, s[8:11], s53 offen offset:1024 sc1
    buffer_load_dwordx2 v[226:227], v6, s[8:11], s53 offen offset:1280 sc1
    buffer_load_dwordx2 v[228:229], v6, s[8:11], s53 offen offset:1536 sc1
    s_waitcnt vmcnt(5)
    v_add_f32 v216, v216, v218
    v_add_f32 v217, v217, v219
    s_waitcnt vmcnt(4)
    v_add_f32 v216, v216, v220
    v_add_f32 v217, v217, v221
    s_waitcnt vmcnt(3)
    v_add_f32 v216, v216, v222
    v_add_f32 v217, v217, v223
    s_waitcnt vmcnt(2)
    v_add_f32 v216, v216, v224
    v_add_f32 v217, v217, v225
    s_waitcnt vmcnt(1)
    v_add_f32 v216, v216, v226
    v_add_f32 v217, v217, v227
    s_waitcnt vmcnt(0)
    v_add_f32 v216, v216, v228
    v_add_f32 v217, v217, v229
    v_mov_b32 v218, v216
    s_nop 1
    v_permlane32_swap_b32 v216, v218
    v_add_f32 v216, v216, v218
    v_mov_b32 v219, v217
    s_nop 1
    v_permlane32_swap_b32 v217, v219
    v_add_f32 v217, v217, v219
    v_mul_f32 v221, 0xbb124925, v216
    v_mul_f32 v217, 0x3b124925, v217
    v_fma_f32 v217, v221, -v221, v217
    v_max_f32 v217, 0, v217
    v_add_f32 v218, 0x3727c5ac, v217
    v_rsq_f32 v8, v218
    s_nop 0
    v_mul_f32 v219, v8, v8
    v_mov_b32 v220, 0x3727c5ac
    v_fmac_f32 v220, v219, v217
    v_rsq_f32 v220, v220
    s_nop 0
    v_mul_f32 v8, v8, v220
    v_mul_f32 v248, 0xc0135761, v8
    v_mul_f32 v249, v8, v8
    v_mul_f32 v249, v249, v248
    v_mul_f32 v249, 0x3d372713, v249
    v_rcp_f32 v250, v8
    v_add_u32 v252, s69, v2
    v_add_u32 v253, s70, v2
    s_cmp_eq_u32 s50, 1
    s_cbranch_scc1 L_hw2s2
    s_lshr_b32 s55, s46, 1
    s_mul_i32 s55, s55, 14336
    s_and_b32 s56, s46, 1
    s_xor_b32 s56, s56, s62
    s_lshl_b32 s56, s56, 6
    s_add_u32 s55, s55, s56
    s_lshr_b32 s52, s62, 1
    s_sub_u32 s53, s45, s52
    s_add_u32 s54, s52, 0
    s_sub_u32 s56, s54, 7
    s_cmp_ge_u32 s54, 7
    s_cselect_b32 s54, s56, s54
    s_add_u32 s54, s54, s53
    s_mul_i32 s54, s54, 114688
    s_add_u32 s54, s54, s55
    s_add_u32 s56, s54, 57344
    buffer_load_dwordx4 v[76:79], v5, s[20:23], s56 offen nt
    s_add_u32 s56, s54, 0
    buffer_load_dwordx4 v[20:23], v5, s[20:23], s56 offen nt
    s_add_u32 s56, s54, 86016
    buffer_load_dwordx4 v[104:107], v5, s[20:23], s56 offen nt
    s_add_u32 s56, s54, 28672
    buffer_load_dwordx4 v[48:51], v5, s[20:23], s56 offen nt
    s_add_u32 s54, s52, 1
    s_sub_u32 s56, s54, 7
    s_cmp_ge_u32 s54, 7
    s_cselect_b32 s54, s56, s54
    s_add_u32 s54, s54, s53
    s_mul_i32 s54, s54, 114688
    s_add_u32 s54, s54, s55
    s_add_u32 s56, s54, 57344
    buffer_load_dwordx4 v[80:83], v5, s[20:23], s56 offen nt
    s_add_u32 s56, s54, 0
    buffer_load_dwordx4 v[24:27], v5, s[20:23], s56 offen nt
    s_add_u32 s56, s54, 86016
    buffer_load_dwordx4 v[108:111], v5, s[20:23], s56 offen nt
    s_add_u32 s56, s54, 28672
    buffer_load_dwordx4 v[52:55], v5, s[20:23], s56 offen nt
    s_add_u32 s54, s52, 2
    s_sub_u32 s56, s54, 7
    s_cmp_ge_u32 s54, 7
    s_cselect_b32 s54, s56, s54
    s_add_u32 s54, s54, s53
    s_mul_i32 s54, s54, 114688
    s_add_u32 s54, s54, s55
    s_add_u32 s56, s54, 57344
    buffer_load_dwordx4 v[84:87], v5, s[20:23], s56 offen nt
    s_add_u32 s56, s54, 0
    buffer_load_dwordx4 v[28:31], v5, s[20:23], s56 offen nt
    s_add_u32 s56, s54, 86016
    buffer_load_dwordx4 v[112:115], v5, s[20:23], s56 offen nt
    s_add_u32 s56, s54, 28672
    buffer_load_dwordx4 v[56:59], v5, s[20:23], s56 offen nt
    s_add_u32 s54, s52, 3
    s_sub_u32 s56, s54, 7
    s_cmp_ge_u32 s54, 7
    s_cselect_b32 s54, s56, s54
    s_add_u32 s54, s54, s53
    s_mul_i32 s54, s54, 114688
    s_add_u32 s54, s54, s55
    s_add_u32 s56, s54, 57344
    buffer_load_dwordx4 v[88:91], v5, s[20:23], s56 offen nt
    s_add_u32 s56, s54, 0
    buffer_load_dwordx4 v[32:35], v5, s[20:23], s56 offen nt
    s_add_u32 s56, s54, 86016
    buffer_load_dwordx4 v[116:119], v5, s[20:23], s56 offen nt
    s_add_u32 s56, s54, 28672
    buffer_load_dwordx4 v[60:63], v5, s[20:23], s56 offen nt
    s_add_u32 s54, s52, 4
    s_sub_u32 s56, s54, 7
    s_cmp_ge_u32 s54, 7
    s_cselect_b32 s54, s56, s54
    s_add_u32 s54, s54, s53
    s_mul_i32 s54, s54, 114688
    s_add_u32 s54, s54, s55
    s_add_u32 s56, s54, 57344
    buffer_load_dwordx4 v[92:95], v5, s[20:23], s56 offen nt
    s_add_u32 s56, s54, 0
    buffer_load_dwordx4 v[36:39], v5, s[20:23], s56 offen nt
    s_add_u32 s56, s54, 86016
    buffer_load_dwordx4 v[120:123], v5, s[20:23], s56 offen nt
    s_add_u32 s56, s54, 28672
    buffer_load_dwordx4 v[64:67], v5, s[20:23], s56 offen nt
    s_add_u32 s54, s52, 5
    s_sub_u32 s56, s54, 7
    s_cmp_ge_u32 s54, 7
    s_cselect_b32 s54, s56, s54
    s_add_u32 s54, s54, s53
    s_mul_i32 s54, s54, 114688
    s_add_u32 s54, s54, s55
    s_add_u32 s56, s54, 57344
    buffer_load_dwordx4 v[96:99], v5, s[20:23], s56 offen nt
    s_add_u32 s56, s54, 0
    buffer_load_dwordx4 v[40:43], v5, s[20:23], s56 offen nt
    s_add_u32 s56, s54, 86016
    buffer_load_dwordx4 v[124:127], v5, s[20:23], s56 offen nt
    s_add_u32 s56, s54, 28672
    buffer_load_dwordx4 v[68:71], v5, s[20:23], s56 offen nt
    s_add_u32 s54, s52, 6
    s_sub_u32 s56, s54, 7
    s_cmp_ge_u32 s54, 7
    s_cselect_b32 s54, s56, s54
    s_add_u32 s54, s54, s53
    s_mul_i32 s54, s54, 114688
    s_add_u32 s54, s54, s55
    s_add_u32 s56, s54, 57344
    buffer_load_dwordx4 v[100:103], v5, s[20:23], s56 offen nt
    s_add_u32 s56, s54, 0
    buffer_load_dwordx4 v[44:47], v5, s[20:23], s56 offen nt
    s_add_u32 s56, s54, 86016
    buffer_load_dwordx4 v[128:131], v5, s[20:23], s56 offen nt
    s_add_u32 s56, s54, 28672
    buffer_load_dwordx4 v[72:75], v5, s[20:23], s56 offen nt
L_hw2s2:
    s_barrier
    ds_read_b128 v[216:219], v14 offset:0
    ds_read_b128 v[220:223], v14 offset:1024
    s_waitcnt lgkmcnt(1)
    v_lshlrev_b32 v232, 16, v216
    v_and_b32 v233, 0xffff0000, v216
    v_lshlrev_b32 v234, 16, v217
    v_and_b32 v235, 0xffff0000, v217
    v_lshlrev_b32 v236, 16, v218
    v_and_b32 v237, 0xffff0000, v218
    v_lshlrev_b32 v238, 16, v219
    v_and_b32 v239, 0xffff0000, v219
    v_mul_f32 v240, v232, v232
    v_mul_f32 v241, v233, v233
    v_mul_f32 v242, v234, v234
    v_mul_f32 v243, v235, v235
    v_mul_f32 v244, v236, v236
    v_mul_f32 v245, v237, v237
    v_mul_f32 v246, v238, v238
    v_mul_f32 v247, v239, v239
    v_fma_f32 v240, v240, v249, v248
    v_fma_f32 v241, v241, v249, v248
    v_fma_f32 v242, v242, v249, v248
    v_fma_f32 v243, v243, v249, v248
    v_fma_f32 v244, v244, v249, v248
    v_fma_f32 v245, v245, v249, v248
    v_fma_f32 v246, v246, v249, v248
    v_fma_f32 v247, v247, v249, v248
    v_mul_f32 v240, v240, v232
    v_mul_f32 v241, v241, v233
    v_mul_f32 v242, v242, v234
    v_mul_f32 v243, v243, v235
    v_mul_f32 v244, v244, v236
    v_mul_f32 v245, v245, v237
    v_mul_f32 v246, v246, v238
    v_mul_f32 v247, v247, v239
    v_exp_f32 v240, v240
    v_exp_f32 v241, v241
    v_exp_f32 v242, v242
    v_exp_f32 v243, v243
    v_exp_f32 v244, v244
    v_exp_f32 v245, v245
    v_exp_f32 v246, v246
    v_exp_f32 v247, v247
    v_fma_f32 v240, v240, v250, v250
    v_fma_f32 v241, v241, v250, v250
    v_fma_f32 v242, v242, v250, v250
    v_fma_f32 v243, v243, v250, v250
    v_fma_f32 v244, v244, v250, v250
    v_fma_f32 v245, v245, v250, v250
    v_fma_f32 v246, v246, v250, v250
    v_fma_f32 v247, v247, v250, v250
    v_rcp_f32 v240, v240
    v_rcp_f32 v241, v241
    v_rcp_f32 v242, v242
    v_rcp_f32 v243, v243
    v_rcp_f32 v244, v244
    v_rcp_f32 v245, v245
    v_rcp_f32 v246, v246
    v_rcp_f32 v247, v247
    v_mul_f32 v232, v232, v240
    v_mul_f32 v233, v233, v241
    v_mul_f32 v234, v234, v242
    v_mul_f32 v235, v235, v243
    v_mul_f32 v236, v236, v244
    v_mul_f32 v237, v237, v245
    v_mul_f32 v238, v238, v246
    v_mul_f32 v239, v239, v247
    v_cvt_pk_bf16_f32 v216, v232, v233
    v_cvt_pk_bf16_f32 v217, v234, v235
    v_cvt_pk_bf16_f32 v218, v236, v237
    v_cvt_pk_bf16_f32 v219, v238, v239
    s_waitcnt lgkmcnt(0)
    v_lshlrev_b32 v232, 16, v220
    v_and_b32 v233, 0xffff0000, v220
    v_lshlrev_b32 v234, 16, v221
    v_and_b32 v235, 0xffff0000, v221
    v_lshlrev_b32 v236, 16, v222
    v_and_b32 v237, 0xffff0000, v222
    v_lshlrev_b32 v238, 16, v223
    v_and_b32 v239, 0xffff0000, v223
    v_mul_f32 v240, v232, v232
    v_mul_f32 v241, v233, v233
    v_mul_f32 v242, v234, v234
    v_mul_f32 v243, v235, v235
    v_mul_f32 v244, v236, v236
    v_mul_f32 v245, v237, v237
    v_mul_f32 v246, v238, v238
    v_mul_f32 v247, v239, v239
    v_fma_f32 v240, v240, v249, v248
    v_fma_f32 v241, v241, v249, v248
    v_fma_f32 v242, v242, v249, v248
    v_fma_f32 v243, v243, v249, v248
    v_fma_f32 v244, v244, v249, v248
    v_fma_f32 v245, v245, v249, v248
    v_fma_f32 v246, v246, v249, v248
    v_fma_f32 v247, v247, v249, v248
    v_mul_f32 v240, v240, v232
    v_mul_f32 v241, v241, v233
    v_mul_f32 v242, v242, v234
    v_mul_f32 v243, v243, v235
    v_mul_f32 v244, v244, v236
    v_mul_f32 v245, v245, v237
    v_mul_f32 v246, v246, v238
    v_mul_f32 v247, v247, v239
    v_exp_f32 v240, v240
    v_exp_f32 v241, v241
    v_exp_f32 v242, v242
    v_exp_f32 v243, v243
    v_exp_f32 v244, v244
    v_exp_f32 v245, v245
    v_exp_f32 v246, v246
    v_exp_f32 v247, v247
    v_fma_f32 v240, v240, v250, v250
    v_fma_f32 v241, v241, v250, v250
    v_fma_f32 v242, v242, v250, v250
    v_fma_f32 v243, v243, v250, v250
    v_fma_f32 v244, v244, v250, v250
    v_fma_f32 v245, v245, v250, v250
    v_fma_f32 v246, v246, v250, v250
    v_fma_f32 v247, v247, v250, v250
    v_rcp_f32 v240, v240
    v_rcp_f32 v241, v241
    v_rcp_f32 v242, v242
    v_rcp_f32 v243, v243
    v_rcp_f32 v244, v244
    v_rcp_f32 v245, v245
    v_rcp_f32 v246, v246
    v_rcp_f32 v247, v247
    v_mul_f32 v232, v232, v240
    v_mul_f32 v233, v233, v241
    v_mul_f32 v234, v234, v242
    v_mul_f32 v235, v235, v243
    v_mul_f32 v236, v236, v244
    v_mul_f32 v237, v237, v245
    v_mul_f32 v238, v238, v246
    v_mul_f32 v239, v239, v247
    v_cvt_pk_bf16_f32 v220, v232, v233
    v_cvt_pk_bf16_f32 v221, v234, v235
    v_cvt_pk_bf16_f32 v222, v236, v237
    v_cvt_pk_bf16_f32 v223, v238, v239
    s_add_u32 s53, s71, 0
    s_cmp_eq_u32 s94, 1
    s_cbranch_scc1 L_msl15
    buffer_store_dwordx4 v[216:219], v2, s[8:11], s53 offen sc1
    buffer_store_dwordx4 v[220:223], v2, s[8:11], s53 offen offset:1024 sc1
    s_branch L_mse15
L_msl15:
    buffer_store_dwordx4 v[216:219], v2, s[8:11], s53 offen
    buffer_store_dwordx4 v[220:223], v2, s[8:11], s53 offen offset:1024
L_mse15:
    ds_write_b128 v14, v[216:219] offset:0
    ds_write_b128 v14, v[220:223] offset:1024
    s_lshl_b32 s54, s45, 2
    s_add_u32 s54, s54, s49
    s_waitcnt vmcnt(0)
    s_waitcnt vmcnt(0)
    s_mov_b64 exec, 1
    s_cmp_eq_u32 s61, 1
    s_cbranch_scc1 L_msl16
    buffer_store_dword v9, v10, s[8:11], s54 offen offset:256 sc1
    s_branch L_mse16
L_msl16:
    buffer_store_dword v9, v10, s[8:11], s54 offen offset:256
L_mse16:
    s_mov_b64 exec, -1
    ds_write_b128 v253, v[76:79] offset:28672
    ds_write_b128 v253, v[80:83] offset:32768
    ds_write_b128 v253, v[84:87] offset:36864
    ds_write_b128 v253, v[88:91] offset:40960
    ds_write_b128 v253, v[92:95] offset:45056
    ds_write_b128 v253, v[96:99] offset:49152
    ds_write_b128 v253, v[100:103] offset:53248
    ds_write_b128 v253, v[20:23] offset:0
    ds_write_b128 v253, v[24:27] offset:4096
    ds_write_b128 v253, v[28:31] offset:8192
    ds_write_b128 v253, v[32:35] offset:12288
    ds_write_b128 v253, v[36:39] offset:16384
    ds_write_b128 v253, v[40:43] offset:20480
    ds_write_b128 v253, v[44:47] offset:24576
    ds_read_b128 v[224:227], v14 offset:8192
    ds_read_b128 v[228:231], v14 offset:9216
    s_waitcnt lgkmcnt(1)
    v_lshlrev_b32 v232, 16, v224
    v_and_b32 v233, 0xffff0000, v224
    v_lshlrev_b32 v234, 16, v225
    v_and_b32 v235, 0xffff0000, v225
    v_lshlrev_b32 v236, 16, v226
    v_and_b32 v237, 0xffff0000, v226
    v_lshlrev_b32 v238, 16, v227
    v_and_b32 v239, 0xffff0000, v227
    v_mul_f32 v240, v232, v232
    v_mul_f32 v241, v233, v233
    v_mul_f32 v242, v234, v234
    v_mul_f32 v243, v235, v235
    v_mul_f32 v244, v236, v236
    v_mul_f32 v245, v237, v237
    v_mul_f32 v246, v238, v238
    v_mul_f32 v247, v239, v239
    v_fma_f32 v240, v240, v249, v248
    v_fma_f32 v241, v241, v249, v248
    v_fma_f32 v242, v242, v249, v248
    v_fma_f32 v243, v243, v249, v248
    v_fma_f32 v244, v244, v249, v248
    v_fma_f32 v245, v245, v249, v248
    v_fma_f32 v246, v246, v249, v248
    v_fma_f32 v247, v247, v249, v248
    v_mul_f32 v240, v240, v232
    v_mul_f32 v241, v241, v233
    v_mul_f32 v242, v242, v234
    v_mul_f32 v243, v243, v235
    v_mul_f32 v244, v244, v236
    v_mul_f32 v245, v245, v237
    v_mul_f32 v246, v246, v238
    v_mul_f32 v247, v247, v239
    v_exp_f32 v240, v240
    v_exp_f32 v241, v241
    v_exp_f32 v242, v242
    v_exp_f32 v243, v243
    v_exp_f32 v244, v244
    v_exp_f32 v245, v245
    v_exp_f32 v246, v246
    v_exp_f32 v247, v247
    v_fma_f32 v240, v240, v250, v250
    v_fma_f32 v241, v241, v250, v250
    v_fma_f32 v242, v242, v250, v250
    v_fma_f32 v243, v243, v250, v250
    v_fma_f32 v244, v244, v250, v250
    v_fma_f32 v245, v245, v250, v250
    v_fma_f32 v246, v246, v250, v250
    v_fma_f32 v247, v247, v250, v250
    v_rcp_f32 v240, v240
    v_rcp_f32 v241, v241
    v_rcp_f32 v242, v242
    v_rcp_f32 v243, v243
    v_rcp_f32 v244, v244
    v_rcp_f32 v245, v245
    v_rcp_f32 v246, v246
    v_rcp_f32 v247, v247
    v_mul_f32 v232, v232, v240
    v_mul_f32 v233, v233, v241
    s_waitcnt lgkmcnt(0)
    s_barrier
    v_mul_f32 v234, v234, v242
    v_mul_f32 v235, v235, v243
    v_mul_f32 v236, v236, v244
    v_mul_f32 v237, v237, v245
    v_mul_f32 v238, v238, v246
    v_mul_f32 v239, v239, v247
    v_cvt_pk_bf16_f32 v224, v232, v233
    v_cvt_pk_bf16_f32 v225, v234, v235
    v_cvt_pk_bf16_f32 v226, v236, v237
    v_cvt_pk_bf16_f32 v227, v238, v239
    v_lshlrev_b32 v232, 16, v228
    v_and_b32 v233, 0xffff0000, v228
    v_lshlrev_b32 v234, 16, v229
    v_and_b32 v235, 0xffff0000, v229
    v_lshlrev_b32 v236, 16, v230
    v_and_b32 v237, 0xffff0000, v230
    v_lshlrev_b32 v238, 16, v231
    v_and_b32 v239, 0xffff0000, v231
    v_mul_f32 v240, v232, v232
    v_mul_f32 v241, v233, v233
    v_mul_f32 v242, v234, v234
    v_mul_f32 v243, v235, v235
    v_mul_f32 v244, v236, v236
    v_mul_f32 v245, v237, v237
    v_mul_f32 v246, v238, v238
    v_mul_f32 v247, v239, v239
    v_fma_f32 v240, v240, v249, v248
    v_fma_f32 v241, v241, v249, v248
    v_fma_f32 v242, v242, v249, v248
    v_fma_f32 v243, v243, v249, v248
    v_fma_f32 v244, v244, v249, v248
    v_fma_f32 v245, v245, v249, v248
    v_fma_f32 v246, v246, v249, v248
    v_fma_f32 v247, v247, v249, v248
    v_mul_f32 v240, v240, v232
    v_mul_f32 v241, v241, v233
    v_mul_f32 v242, v242, v234
    v_mul_f32 v243, v243, v235
    v_mul_f32 v244, v244, v236
    v_mul_f32 v245, v245, v237
    v_mul_f32 v246, v246, v238
    v_mul_f32 v247, v247, v239
    v_exp_f32 v240, v240
    v_exp_f32 v241, v241
    v_exp_f32 v242, v242
    v_exp_f32 v243, v243
    v_exp_f32 v244, v244
    v_exp_f32 v245, v245
    v_exp_f32 v246, v246
    v_exp_f32 v247, v247
    v_fma_f32 v240, v240, v250, v250
    v_fma_f32 v241, v241, v250, v250
    v_fma_f32 v242, v242, v250, v250
    v_fma_f32 v243, v243, v250, v250
    v_fma_f32 v244, v244, v250, v250
    v_fma_f32 v245, v245, v250, v250
    v_fma_f32 v246, v246, v250, v250
    v_fma_f32 v247, v247, v250, v250
    v_rcp_f32 v240, v240
    v_rcp_f32 v241, v241
    v_rcp_f32 v242, v242
    v_rcp_f32 v243, v243
    v_rcp_f32 v244, v244
    v_rcp_f32 v245, v245
    v_rcp_f32 v246, v246
    v_rcp_f32 v247, v247
    v_mul_f32 v232, v232, v240
    v_mul_f32 v233, v233, v241
    v_mul_f32 v234, v234, v242
    v_mul_f32 v235, v235, v243
    v_mul_f32 v236, v236, v244
    v_mul_f32 v237, v237, v245
    v_mul_f32 v238, v238, v246
    v_mul_f32 v239, v239, v247
    v_cvt_pk_bf16_f32 v228, v232, v233
    v_cvt_pk_bf16_f32 v229, v234, v235
    v_cvt_pk_bf16_f32 v230, v236, v237
    v_cvt_pk_bf16_f32 v231, v238, v239
    s_add_u32 s53, s71, 2048
    s_cmp_eq_u32 s94, 1
    s_cbranch_scc1 L_msl17
    buffer_store_dwordx4 v[224:227], v2, s[8:11], s53 offen sc1
    buffer_store_dwordx4 v[228:231], v2, s[8:11], s53 offen offset:1024 sc1
    s_branch L_mse17
L_msl17:
    buffer_store_dwordx4 v[224:227], v2, s[8:11], s53 offen
    buffer_store_dwordx4 v[228:231], v2, s[8:11], s53 offen offset:1024
L_mse17:
    ds_write_b128 v14, v[224:227] offset:8192
    ds_write_b128 v14, v[228:231] offset:9216
    ds_write_b128 v252, v[104:107] offset:0
    ds_write_b128 v252, v[108:111] offset:4096
    ds_write_b128 v252, v[112:115] offset:8192
    ds_write_b128 v252, v[116:119] offset:12288
    ds_write_b128 v252, v[120:123] offset:16384
    ds_write_b128 v252, v[124:127] offset:20480
    ds_write_b128 v252, v[128:131] offset:24576
    s_lshl_b32 s54, s45, 2
    s_add_u32 s54, s54, s49
    s_waitcnt vmcnt(0)
    s_waitcnt vmcnt(0)
    s_mov_b64 exec, 1
    s_cmp_eq_u32 s61, 1
    s_cbranch_scc1 L_msl18
    buffer_store_dword v9, v10, s[8:11], s54 offen offset:320 sc1
    s_branch L_mse18
L_msl18:
    buffer_store_dword v9, v10, s[8:11], s54 offen offset:320
L_mse18:
    s_mov_b64 exec, -1
    ds_write_b128 v252, v[48:51] offset:28672
    ds_write_b128 v252, v[52:55] offset:32768
    ds_write_b128 v252, v[56:59] offset:36864
    ds_write_b128 v252, v[60:63] offset:40960
    ds_write_b128 v252, v[64:67] offset:45056
    ds_write_b128 v252, v[68:71] offset:49152
    ds_write_b128 v252, v[72:75] offset:53248
    s_waitcnt lgkmcnt(0)
    s_barrier
    s_cmp_eq_u32 s50, 1
    s_cbranch_scc1 L_hnext
    ds_write_b128 v253, v[132:135] offset:0
    ds_write_b128 v253, v[136:139] offset:4096
    ds_write_b128 v253, v[140:143] offset:8192
    ds_write_b128 v253, v[144:147] offset:12288
    ds_write_b128 v253, v[148:151] offset:16384
    ds_write_b128 v253, v[152:155] offset:20480
    ds_write_b128 v253, v[156:159] offset:24576
    ds_write_b128 v253, v[160:163] offset:28672
    ds_write_b128 v253, v[164:167] offset:32768
    ds_write_b128 v253, v[168:171] offset:36864
    ds_write_b128 v253, v[172:175] offset:40960
    ds_write_b128 v253, v[176:179] offset:45056
    ds_write_b128 v253, v[180:183] offset:49152
    ds_write_b128 v253, v[184:187] offset:53248
    s_waitcnt vmcnt(0) lgkmcnt(0)
    v_mov_b32 v222, 132548
    s_mov_b32 s51, 0
L_hwq:
    ds_read_b32 v220, v222
    s_add_u32 s51, s51, 1
    s_cmp_gt_u32 s51, 0x1000000
    s_cbranch_scc1 L_end
    s_waitcnt lgkmcnt(0)
    v_readfirstlane_b32 s56, v220
    s_nop 3
    s_cmp_lt_u32 s56, 8
    s_cbranch_scc1 L_hwq
    ds_write_b128 v252, v[188:191] offset:0
    ds_write_b128 v252, v[192:195] offset:4096
    ds_write_b128 v252, v[196:199] offset:8192
    ds_write_b128 v252, v[200:203] offset:12288
    ds_write_b128 v252, v[204:207] offset:16384
    ds_write_b128 v252, v[208:211] offset:20480
    ds_write_b128 v252, v[212:215] offset:24576
    s_waitcnt lgkmcnt(0)
L_hnext:
    s_cmp_eq_u32 s50, 1
    s_cbranch_scc1 L_end
    s_mov_b32 s50, 1
    s_add_u32 s49, s49, 180224
    s_add_u32 s65, s65, 4194304
    s_mov_b32 s63, 57344
    s_mov_b32 s64, 0
    s_branch L_hloop
L_sub_ps:
    v_add_u32 v216, s90, v16
    v_mov_b32 v220, 0x3f803f80
    v_mov_b32 v221, 0x3f803f80
    v_mov_b32 v222, 0x3f803f80
    v_mov_b32 v223, 0x3f803f80
    v_mov_b32 v240, 0
    v_mov_b32 v241, 0
    v_mov_b32 v242, 0
    v_mov_b32 v243, 0
    v_mov_b32 v244, 0
    v_mov_b32 v245, 0
    v_mov_b32 v246, 0
    v_mov_b32 v247, 0
    v_mov_b32 v248, 0
    v_mov_b32 v249, 0
    v_mov_b32 v250, 0
    v_mov_b32 v251, 0
    v_mov_b32 v252, 0
    v_mov_b32 v253, 0
    v_mov_b32 v254, 0
    v_mov_b32 v255, 0
L_ps_loop:
    ds_read_b64_tr_b16 v[224:225], v216 offset:0
    ds_read_b64_tr_b16 v[226:227], v216 offset:512
    ds_read_b64_tr_b16 v[228:229], v216 offset:4096
    ds_read_b64_tr_b16 v[230:231], v216 offset:4608
    ds_read_b64_tr_b16 v[232:233], v216 offset:8192
    ds_read_b64_tr_b16 v[234:235], v216 offset:8704
    ds_read_b64_tr_b16 v[236:237], v216 offset:12288
    ds_read_b64_tr_b16 v[238:239], v216 offset:12800
    s_waitcnt lgkmcnt(6)
    v_mfma_f32_32x32x16_bf16 v[240:255], v[224:227], v[220:223], v[240:255]
    ds_read_b64_tr_b16 v[224:225], v216 offset:16384
    ds_read_b64_tr_b16 v[226:227], v216 offset:16896
    s_waitcnt lgkmcnt(6)
    v_mfma_f32_32x32x16_bf16 v[240:255], v[228:231], v[220:223], v[240:255]
    ds_read_b64_tr_b16 v[228:229], v216 offset:20480
    ds_read_b64_tr_b16 v[230:231], v216 offset:20992
    s_waitcnt lgkmcnt(6)
    v_mfma_f32_32x32x16_bf16 v[240:255], v[232:235], v[220:223], v[240:255]
    ds_read_b64_tr_b16 v[232:233], v216 offset:24576
    ds_read_b64_tr_b16 v[234:235], v216 offset:25088
    s_waitcnt lgkmcnt(6)
    v_mfma_f32_32x32x16_bf16 v[240:255], v[236:239], v[220:223], v[240:255]
    s_waitcnt lgkmcnt(4)
    v_mfma_f32_32x32x16_bf16 v[240:255], v[224:227], v[220:223], v[240:255]
    s_waitcnt lgkmcnt(2)
    v_mfma_f32_32x32x16_bf16 v[240:255], v[228:231], v[220:223], v[240:255]
    s_waitcnt lgkmcnt(0)
    v_mfma_f32_32x32x16_bf16 v[240:255], v[232:235], v[220:223], v[240:255]
    v_add_u32 v216, 28672, v216
    s_sub_u32 s91, s91, 7
    s_cmp_lg_u32 s91, 0
    s_cbranch_scc1 L_ps_loop
    v_lshrrev_b32 v216, 5, v1
    v_lshlrev_b32 v216, 4, v216
    v_add_u32 v216, s92, v216
    s_mov_b32 s58, 1
    s_mov_b32 s59, 1
    s_mov_b64 exec, s[58:59]
    s_nop 1
    ds_write_b128 v216, v[240:243] offset:0
    ds_write_b128 v216, v[244:247] offset:32
    ds_write_b128 v216, v[248:251] offset:64
    ds_write_b128 v216, v[252:255] offset:96
    s_mov_b64 exec, -1
    s_waitcnt lgkmcnt(0)
    s_setpc_b64 s[88:89]
L_sub_cv:
    v_and_b32 v216, 3, v1
    v_lshlrev_b32 v216, 5, v216
    v_add_u32 v216, s90, v216
    ds_read_b128 v[232:235], v216 offset:0
    ds_read_b128 v[236:239], v216 offset:16
    ds_read_b128 v[248:251], v216 offset:128
    ds_read_b128 v[252:255], v216 offset:144
    s_waitcnt lgkmcnt(1)
    v_add_f32 v232, v232, v248
    v_add_f32 v233, v233, v249
    v_add_f32 v234, v234, v250
    v_add_f32 v235, v235, v251
    s_waitcnt lgkmcnt(0)
    v_add_f32 v236, v236, v252
    v_add_f32 v237, v237, v253
    v_add_f32 v238, v238, v254
    v_add_f32 v239, v239, v255
    ds_read_b128 v[240:243], v216 offset:256
    ds_read_b128 v[244:247], v216 offset:272
    s_waitcnt lgkmcnt(1)
    v_add_f32 v232, v232, v240
    v_add_f32 v233, v233, v241
    v_add_f32 v234, v234, v242
    v_add_f32 v235, v235, v243
    s_waitcnt lgkmcnt(0)
    v_add_f32 v236, v236, v244
    v_add_f32 v237, v237, v245
    v_add_f32 v238, v238, v246
    v_add_f32 v239, v239, v247
    ds_read_b128 v[248:251], v216 offset:384
    ds_read_b128 v[252:255], v216 offset:400
    s_waitcnt lgkmcnt(1)
    v_add_f32 v232, v232, v248
    v_add_f32 v233, v233, v249
    v_add_f32 v234, v234, v250
    v_add_f32 v235, v235, v251
    s_waitcnt lgkmcnt(0)
    v_add_f32 v236, v236, v252
    v_add_f32 v237, v237, v253
    v_add_f32 v238, v238, v254
    v_add_f32 v239, v239, v255
    v_cvt_pk_bf16_f32 v220, v232, v233
    v_cvt_pk_bf16_f32 v221, v234, v235
    v_cvt_pk_bf16_f32 v222, v236, v237
    v_cvt_pk_bf16_f32 v223, v238, v239
    v_lshlrev_b32 v218, 16, v220
    v_and_b32 v219, 0xffff0000, v220
    v_sub_f32 v218, v232, v218
    v_sub_f32 v219, v233, v219
    v_cvt_pk_bf16_f32 v224, v218, v219
    v_lshlrev_b32 v218, 16, v221
    v_and_b32 v219, 0xffff0000, v221
    v_sub_f32 v218, v234, v218
    v_sub_f32 v219, v235, v219
    v_cvt_pk_bf16_f32 v225, v218, v219
    v_lshlrev_b32 v218, 16, v222
    v_and_b32 v219, 0xffff0000, v222
    v_sub_f32 v218, v236, v218
    v_sub_f32 v219, v237, v219
    v_cvt_pk_bf16_f32 v226, v218, v219
    v_lshlrev_b32 v218, 16, v223
    v_and_b32 v219, 0xffff0000, v223
    v_sub_f32 v218, v238, v218
    v_sub_f32 v219, v239, v219
    v_cvt_pk_bf16_f32 v227, v218, v219
    v_and_b32 v218, 4, v1
    v_cmp_eq_u32 vcc, 4, v218
    s_nop 1
    v_cndmask_b32 v220, v220, v224, vcc
    v_cndmask_b32 v221, v221, v225, vcc
    v_cndmask_b32 v222, v222, v226, vcc
    v_cndmask_b32 v223, v223, v227, vcc
    v_add_u32 v216, s92, v2
    s_mov_b64 exec, 0xffff
    ds_write_b128 v216, v[220:223]
    s_mov_b64 exec, -1
    s_waitcnt lgkmcnt(0)
    s_setpc_b64 s[88:89]
L_end:
    s_endpgm
.section .rodata,"a"
.p2align 6
.amdhsa_kernel interleave_layers__sliding_block__mixer_channel_mlp__prompt_kernel
  .amdhsa_next_free_vgpr 256
  .amdhsa_next_free_sgpr 96
  .amdhsa_accum_offset 256
  .amdhsa_group_segment_fixed_size 0
  .amdhsa_kernarg_size 88
  .amdhsa_user_sgpr_count 2
  .amdhsa_user_sgpr_kernarg_segment_ptr 1
  .amdhsa_system_sgpr_workgroup_id_x 1
.end_amdhsa_kernel
```
